```python
import torch

def _softmax(x, axis=-1):
    return torch.softmax(x, dim=axis)
def _gelu(x):
    return torch.nn.functional.gelu(x, approximate="tanh")
def _silu(x):
    return torch.nn.functional.silu(x)
def _sigmoid(x):
    return torch.sigmoid(x)
def _layernorm(x, axis=-1, eps=1e-5):
    m = x.mean(dim=axis, keepdim=True)
    v = x.var(dim=axis, keepdim=True, unbiased=False)
    return (x - m) / torch.sqrt(v + eps)
def _scatter_add(tgt, idx, src, axis=0):
    return tgt.clone().index_add_(axis, idx, src)
def _segment_sum(src, seg, n):
    out = torch.zeros((n,) + src.shape[1:], dtype=src.dtype)
    return out.index_add_(0, seg, src)
def _pad(x, pw):
    flat = tuple(v for pair in reversed(pw) for v in pair)
    return torch.nn.functional.pad(x, flat)

kernel_name = 'gated_mix__linear_kernel_hedgehog__dense_activation_silu__prompt'

def setup_inputs():

    _w = (lambda a: (lambda t: t.to(torch.bfloat16) if t.is_floating_point() else t)(torch.as_tensor(a)))
    def _A_setup():
        B, S, D, H = 1, 2048, 448, 16
        Dh = D // H
        return {
            "x": _w((lambda *s: torch.randn(*s, dtype=torch.bfloat16) * 0.05)(B, S, D)),
            "wqkv": _w((lambda *s: torch.randn(*s, dtype=torch.bfloat16) * 0.8)(D, 3 * D)),
            "w_phi": _w((lambda *s: torch.randn(*s, dtype=torch.bfloat16) * 0.8)(H, Dh, Dh) * (Dh ** -0.5)),
            "wo": _w((lambda *s: torch.randn(*s, dtype=torch.bfloat16) * 0.05)(D, D)),
        }
    _A_in = _A_setup()

    def _B_setup():
        B, S, D, F = 1, 2048, 448, 1792
        return {
            "x": _w((lambda *s: torch.randn(*s, dtype=torch.bfloat16) * 0.05)(B, S, D)),
            "w1": _w((lambda *s: torch.randn(*s, dtype=torch.bfloat16) * 3.2)(D, F) * (D ** -0.5)),
            "w2": _w((lambda *s: torch.randn(*s, dtype=torch.bfloat16) * 0.2)(F, D) * (F ** -0.5)),
        }
    _B_in = _B_setup()

    return {
        "A_x": _A_in["x"],
        "A_wqkv": _A_in["wqkv"],
        "A_w_phi": _A_in["w_phi"],
        "A_wo": _A_in["wo"],
        "B_x": _B_in["x"],
        "B_w1": _B_in["w1"],
        "B_w2": _B_in["w2"],
        "gate_w": _w((lambda *s: torch.randn(*s, dtype=torch.bfloat16) * 0.05)(448) * 16.0),
    }

def reference(A_x, A_wqkv, A_w_phi, A_wo, B_x, B_w1, B_w2, gate_w):
    def _A_ref(x, wqkv, w_phi, wo):
        B, S, D = x.shape
        H = 16; Dh = D // H
        qkv = (lambda x, *d: x.permute(*d))((x @ wqkv).reshape(B, S, 3, H, Dh), 2, 0, 3, 1, 4)
        q, k, v = qkv[0], qkv[1], qkv[2]
        pq = torch.einsum("bhsd,hdf->bhsf", q, w_phi)
        pk = torch.einsum("bhsd,hdf->bhsf", k, w_phi)
        phi_q = torch.concatenate([_softmax(pq, axis=-1), _softmax(-pq, axis=-1)], axis=-1)
        phi_k = torch.concatenate([_softmax(pk, axis=-1), _softmax(-pk, axis=-1)], axis=-1)
        kv = torch.einsum("bhsf,bhsd->bhfd", phi_k, v)
        z  = torch.einsum("bhsf->bhf", phi_k)
        num = torch.einsum("bhqf,bhfd->bhqd", phi_q, kv)
        den = torch.einsum("bhqf,bhf->bhq", phi_q, z)[..., None] + 1e-6
        o = num / den
        return (lambda x, *d: x.permute(*d))(o, 0, 2, 1, 3).reshape(B, S, D) @ wo

    def _B_ref(x, w1, w2):
        h = torch.einsum("bsd,df->bsf", x, w1)
        h = _silu(h)
        out = torch.einsum("bsf,fd->bsd", h, w2)
        return out

    x = A_x
    g = _sigmoid((x * gate_w).sum(-1, keepdims=True))
    a = _A_ref(x, A_wqkv, A_w_phi, A_wo)
    b = _B_ref(x, B_w1, B_w2)
    return g * a + (1 - g) * b
```

```asm
; @launch grid=(256,1,1) block=(512,1,1) lds=163840
.amdgcn_target "amdgcn-amd-amdhsa--gfx950"
.text
.globl gated_mix__linear_kernel_hedgehog__dense_activation_silu__prompt_kernel
.p2align 8
.type gated_mix__linear_kernel_hedgehog__dense_activation_silu__prompt_kernel,@function
gated_mix__linear_kernel_hedgehog__dense_activation_silu__prompt_kernel:
    s_cmp_ge_u32 s2, 256
    s_cbranch_scc1 END
    s_load_dwordx16 s[4:19], s[0:1], 0
    s_load_dwordx4 s[20:23], s[0:1], 64
    s_load_dwordx2 s[24:25], s[0:1], 80
    v_lshrrev_b32 v30, 6, v0
    v_and_b32 v0, 63, v0
    s_and_b32 s87, s2, 7
    s_lshr_b32 s88, s2, 3
    v_readfirstlane_b32 s74, v30
    s_lshr_b32 s72, s87, 1
    s_lshr_b32 s89, s88, 3
    s_lshl2_add_u32 s72, s72, s89
    s_and_b32 s73, s87, 1
    s_and_b32 s76, s88, 7
    s_lshl3_add_u32 s73, s73, s76
    s_and_b32 s78, s74, 3
    s_lshr_b32 s79, s74, 2
    v_lshlrev_b32 v1, 4, v0
    v_lshrrev_b32 v30, 3, v0
    v_and_b32 v31, 7, v0
    v_lshrrev_b32 v136, 4, v0
    v_xor_b32 v137, v31, v136
    v_mul_u32_u24 v2, 896, v30
    v_xor_b32 v3, 4, v137
    v_lshl_add_u32 v3, v3, 4, v2
    v_lshl_add_u32 v2, v137, 4, v2
    v_add_u32 v3, 6144, v3
    v_and_b32 v136, 1, v136
    v_lshlrev_b32 v136, 2, v136
    v_xor_b32 v137, v31, v136
    v_mul_u32_u24 v4, 3584, v30
    v_lshl_add_u32 v4, v137, 4, v4
    v_add_u32 v5, 27648, v4
    v_mul_u32_u24 v6, 896, v30
    v_lshl_add_u32 v6, v137, 4, v6
    v_add_u32 v140, 6144, v6
    s_mul_i32 s80, s78, 28672
    s_lshl_b32 s87, s79, 11
    s_add_u32 s81, s80, s87
    s_lshl_b32 s82, s78, 11
    s_add_u32 s82, s82, 114688
    s_lshl_b32 s87, s73, 1
    s_add_u32 s88, s73, 12
    s_cmp_lt_u32 s73, 12
    s_cselect_b32 s84, s87, s88
    s_add_u32 s87, s87, 1
    s_cmp_eq_u32 s79, 1
    s_cselect_b32 s84, s87, s84
    s_and_b32 s87, s72, 3
    s_lshl1_add_u32 s87, s87, s76
    s_cmp_ge_u32 s87, 7
    s_cselect_b32 s88, 7, 0
    s_sub_u32 s87, s87, s88
    s_lshl_b32 s75, s87, 2
    s_mul_i32 s89, s72, 114688
    s_add_u32 s89, s89, s80
    s_mul_i32 s87, s79, 14336
    s_add_u32 s89, s89, s87
    s_lshl_b32 s88, s84, 7
    s_mul_i32 s87, s78, 57344
    s_add_u32 s88, s88, s87
    s_mov_b32 s26, 0x06543210
    s_mov_b32 s27, 0x00654321
    s_lshr_b64 s[26:27], s[26:27], s75
    s_cmp_ge_u32 s74, 3
    s_cselect_b32 s91, 2147483648, 0
    v_add_u32 v30, 0, v0
    v_lshrrev_b32 v31, 2, v30
    v_and_b32 v136, 3, v0
    v_mul_u32_u24 v114, 2688, v31
    v_lshl_add_u32 v114, v136, 4, v114
    v_lshlrev_b32 v116, 4, v30
    v_lshlrev_b32 v118, 1, v31
    v_or_b32 v114, s91, v114
    v_or_b32 v116, s91, v116
    v_or_b32 v118, s91, v118
    v_add_u32 v30, 64, v0
    v_lshrrev_b32 v31, 2, v30
    v_and_b32 v136, 3, v0
    v_mul_u32_u24 v115, 2688, v31
    v_lshl_add_u32 v115, v136, 4, v115
    v_lshlrev_b32 v117, 4, v30
    v_lshlrev_b32 v119, 1, v31
    v_cmp_le_u32 vcc, 48, v0
    v_mov_b32 v137, 2147483648
    s_nop 0
    v_cndmask_b32 v115, v115, v137, vcc
    v_cndmask_b32 v117, v117, v137, vcc
    v_cndmask_b32 v119, v119, v137, vcc
    v_or_b32 v115, s91, v115
    v_or_b32 v117, s91, v117
    v_or_b32 v119, s91, v119
    s_mul_i32 s90, s72, 75264
    s_mul_i32 s92, s74, 896
    s_add_u32 s90, s90, s92
    s_mul_i32 s92, s73, 56
    s_add_u32 s90, s90, s92
    s_mul_i32 s92, s72, 56
    s_waitcnt lgkmcnt(0)
    s_mov_b64 s[36:37], s[6:7]
    s_mov_b32 s38, 1204224
    s_mov_b32 s39, 0x20000
    s_mov_b64 s[68:69], s[18:19]
    s_mov_b32 s70, 896
    s_mov_b32 s71, 0x20000
    buffer_load_dwordx4 v[104:107], v114, s[36:39], s90 offen
    buffer_load_ushort v112, v118, s[68:71], s92 offen
    buffer_load_dwordx4 v[108:111], v115, s[36:39], s90 offen
    buffer_load_ushort v113, v119, s[68:71], s92 offen
    s_and_b32 s13, s26, 0xfffffff
    s_add_u32 s28, s4, s89
    s_addc_u32 s29, s5, 0
    s_sub_u32 s30, 1835008, s89
    s_mov_b32 s31, 0x20000
    s_add_u32 s32, s14, s88
    s_addc_u32 s33, s15, 0
    s_sub_u32 s34, 1605632, s88
    s_cmp_ge_u32 s73, 12
    s_cselect_b32 s87, s79, 0
    s_cmp_eq_u32 s87, 1
    s_cselect_b32 s34, 0, s34
    s_mov_b32 s35, 0x20000
    s_cmp_eq_u32 s79, 1
    s_cbranch_scc1 PATH_B
    s_add_u32 m0, s81, 0
    s_bfe_u32 s92, s13, 262144
    s_lshl_b32 s92, s92, 7
    buffer_load_dwordx4 v2, s[28:31], s92 offen lds
    buffer_load_dwordx4 v3, s[28:31], s92 offen offset:1024 lds
    s_add_u32 m0, s81, 4096
    s_bfe_u32 s92, s13, 262148
    s_lshl_b32 s92, s92, 7
    buffer_load_dwordx4 v2, s[28:31], s92 offen lds
    buffer_load_dwordx4 v3, s[28:31], s92 offen offset:1024 lds
    s_or_b32 s87, s2, s74
    s_cmp_lg_u32 s87, 0
    s_cbranch_scc1 NW_1
    s_memrealtime s[26:27]
    s_waitcnt lgkmcnt(0)
    s_or_b32 s26, s26, 0x80000000
    v_mov_b32 v30, s26
    v_mov_b32 v31, 0
    s_mov_b64 exec, 1
    global_store_dword v31, v30, s[22:23] sc1
    s_mov_b64 exec, -1
NW_1:
    s_mov_b64 s[40:41], s[24:25]
    s_mov_b32 s42, 13631488
    s_mov_b32 s43, 0x20000
    s_mov_b64 s[44:45], s[24:25]
    s_cmp_eq_u32 s34, 0
    s_cselect_b32 s46, 0, 13631488
    s_mov_b32 s47, 0x20000
    s_cmp_lt_u32 s76, 7
    s_cselect_b32 s88, -1, 0
    s_mov_b64 s[48:49], s[24:25]
    s_and_b32 s50, s88, 13631488
    s_mov_b32 s51, 0x20000
    s_lshl_b32 s87, s76, 7
    s_add_u32 s52, s16, s87
    s_addc_u32 s53, s17, 0
    s_sub_u32 s54, 1605632, s87
    s_and_b32 s54, s54, s88
    s_mov_b32 s55, 0x20000
    s_add_u32 s56, s10, s87
    s_addc_u32 s57, s11, 0
    s_sub_u32 s58, 401408, s87
    s_and_b32 s58, s58, s88
    s_mov_b32 s59, 0x20000
    s_mov_b64 s[60:61], s[20:21]
    s_and_b32 s62, s88, 1835008
    s_mov_b32 s63, 0x20000
    s_mul_i32 s87, s73, 1568
    s_add_u32 s64, s8, s87
    s_addc_u32 s65, s9, 0
    s_mov_b32 s66, 1568
    s_mov_b32 s67, 0x20000
    s_bfe_u32 s36, s13, 262144
    s_lshl_b32 s36, s36, 7
    s_bfe_u32 s37, s13, 262148
    s_lshl_b32 s37, s37, 7
    s_bfe_u32 s38, s13, 262152
    s_lshl_b32 s38, s38, 7
    s_bfe_u32 s39, s13, 262156
    s_lshl_b32 s39, s39, 7
    s_bfe_u32 s68, s13, 262160
    s_lshl_b32 s68, s68, 7
    s_bfe_u32 s69, s13, 262164
    s_lshl_b32 s69, s69, 7
    s_bfe_u32 s70, s13, 262168
    s_lshl_b32 s70, s70, 7
    s_add_u32 m0, s81, 8192
    s_nop 0
    buffer_load_dwordx4 v2, s[28:31], s38 offen lds
    buffer_load_dwordx4 v3, s[28:31], s38 offen offset:1024 lds
    v_and_b32 v120, 31, v0
    v_lshrrev_b32 v121, 5, v0
    v_lshrrev_b32 v126, 1, v120
    v_and_b32 v126, 7, v126
    v_xor_b32 v126, v126, v121
    v_lshlrev_b32 v126, 4, v126
    v_lshl_add_u32 v126, v120, 7, v126
    v_add_u32 v7, s80, v126
    v_xor_b32 v8, 32, v126
    v_add_u32 v8, s80, v8
    v_xor_b32 v9, 64, v126
    v_add_u32 v9, s80, v9
    v_xor_b32 v10, 96, v126
    v_add_u32 v10, s80, v10
    v_bfe_u32 v122, v0, 4, 1
    v_bfe_u32 v123, v0, 2, 2
    v_and_b32 v124, 3, v0
    v_lshrrev_b32 v125, 1, v124
    v_lshl_add_u32 v125, v122, 1, v125
    v_lshrrev_b32 v126, 1, v123
    v_lshlrev_b32 v126, 2, v126
    v_xor_b32 v125, v125, v126
    v_lshlrev_b32 v125, 4, v125
    v_and_b32 v126, 1, v124
    v_lshl_add_u32 v125, v126, 3, v125
    v_lshl_add_u32 v126, v121, 3, v123
    v_lshl_add_u32 v126, v126, 7, v125
    v_mov_b32 v13, v126
    v_xor_b32 v14, 64, v126
    v_add_u32 v15, 57344, v13
    v_add_u32 v16, 57344, v14
    v_add_u32 v11, 114688, v13
    v_add_u32 v12, 114688, v14
    v_lshl_add_u32 v126, v121, 2, v123
    v_lshl_add_u32 v126, v126, 7, v125
    v_add_u32 v22, s80, v126
    s_mul_i32 s95, s78, 12288
    s_add_u32 s95, s95, 114688
    v_add_u32 v20, s95, v126
    v_xor_b32 v126, 64, v126
    v_add_u32 v23, s80, v126
    v_add_u32 v21, s95, v126
    v_lshlrev_b32 v127, 3, v124
    v_lshl_add_u32 v127, v122, 5, v127
    v_lshl_add_u32 v126, v121, 3, v123
    v_lshl_add_u32 v18, v126, 6, v127
    v_add_u32 v19, 57344, v18
    v_add_u32 v17, 114688, v18
    v_mul_u32_u24 v24, 136, v120
    v_lshl_add_u32 v24, v121, 3, v24
    v_add_u32 v24, s80, v24
    v_lshl_add_u32 v126, v121, 2, v123
    s_lshr_b32 s87, s78, 1
    s_lshl_b32 s87, s87, 6
    v_mul_u32_u24 v25, 136, v126
    v_add_u32 v25, v25, v127
    v_add_u32 v25, s87, v25
    v_mul_u32_u24 v139, 56, v126
    v_add_u32 v139, v139, v127
    v_add_u32 v139, 26624, v139
    v_cmp_le_u32 s[96:97], 32, v0
    v_cmp_eq_u32 s[98:99], 28, v120
    v_and_b32 v26, 15, v0
    v_lshlrev_b32 v26, 7, v26
    v_min_u32 v141, 47, v0
    v_lshlrev_b32 v141, 7, v141
    s_mul_i32 s94, s73, 28672
    s_lshl_b32 s87, s78, 10
    s_add_u32 s94, s94, s87
    s_add_u32 s94, s94, 65536
    s_add_u32 s88, s79, 1
    s_mul_i32 s88, s88, 458752
    s_add_u32 s83, s94, s88
    s_mul_i32 s93, s79, 28672
    s_add_u32 s93, s93, s87
    s_add_u32 s93, s93, 114688
    s_lshl2_add_u32 s89, s72, s78
    s_mul_i32 s85, s89, 147456
    s_add_u32 s85, s85, 4194304
    s_lshl_b32 s84, s84, 12
    s_add_u32 s84, s84, s85
    s_lshl_b32 s86, s73, 16
    s_add_u32 s86, s86, s87
    s_add_u32 s86, s86, 2097152
    s_lshr_b32 s77, s73, 3
    s_lshl_b32 s77, s77, 1
    s_lshl2_add_u32 s77, s72, s77
    s_mov_b32 s90, 0x3fb8aa3b
    s_mul_i32 s95, s73, 6144
    s_lshl_b32 s87, s74, 11
    s_add_u32 s87, s87, s95
    s_lshl_b32 s21, s72, 7
    s_add_u32 s21, s21, s87
    s_add_u32 s21, s21, 1572864
    s_cmp_ge_u32 s74, 3
    s_cselect_b32 s21, 2147483648, s21
    s_mov_b32 s27, 0xbfb8aa3b
    s_getpc_b64 s[100:101]
PCREF:
    s_lshr_b32 s89, s2, 3
    s_lshl_b32 s89, s89, 10
    v_lshlrev_b32 v31, 7, v0
    v_add_u32 v31, s89, v31
    v_min_u32 v31, END-PCREF, v31
    s_mov_b64 exec, 0xff
    global_load_dword v29, v31, s[100:101]
    s_mov_b64 exec, -1
    s_waitcnt vmcnt(7)
    v_and_b32 v136, 3, v0
    v_cmp_eq_u32 vcc, 3, v136
    s_cmp_eq_u32 s74, 0
    s_cselect_b32 s89, 0xffff, 0
    v_mov_b32 v137, 0
    v_and_b32 v112, s89, v112
    v_cndmask_b32 v106, v106, v112, vcc
    v_cndmask_b32 v107, v107, v137, vcc
    v_and_b32 v113, s89, v113
    v_cndmask_b32 v110, v110, v113, vcc
    v_cndmask_b32 v111, v111, v137, vcc
    s_lshl4_add_u32 s87, s74, s73
    s_mul_i32 s87, s87, 28672
    s_mul_i32 s88, s72, 1792
    s_add_u32 s87, s87, s88
    s_add_u32 s87, s87, 65536
    buffer_store_dwordx4 v[104:107], v116, s[40:43], s87 offen sc1
    buffer_store_dwordx4 v[108:111], v117, s[40:43], s87 offen sc1
    s_nop 0
    v_mov_b32 v104, -1
    v_mov_b32 v105, -1
    v_mov_b32 v106, -1
    v_mov_b32 v107, -1
    s_lshl4_add_u32 s87, s73, s72
    s_lshl_b32 s87, s87, 12
    s_add_u32 s87, s87, 2097152
    s_lshl_b32 s88, s74, 10
    s_add_u32 s88, s88, s87
    s_cmp_ge_u32 s74, 3
    s_cselect_b32 s88, 2147483648, s88
    s_cselect_b32 s87, 2147483648, s87
    buffer_store_dwordx4 v[104:107], v1, s[40:43], s88 offen sc1
    buffer_store_dwordx4 v[104:107], v1, s[40:43], s87 offen offset:3072 sc1
    s_waitcnt vmcnt(9)
    s_barrier
    ds_read_b128 a[0:3], v7 offset:0
    ds_read_b128 a[4:7], v8 offset:0
    ds_read_b128 a[8:11], v9 offset:0
    ds_read_b128 a[12:15], v10 offset:0
    s_waitcnt vmcnt(7) lgkmcnt(0)
    s_barrier
    ds_read_b128 a[16:19], v7 offset:4096
    ds_read_b128 a[20:23], v8 offset:4096
    ds_read_b128 a[24:27], v9 offset:4096
    ds_read_b128 a[28:31], v10 offset:4096
    s_add_u32 m0, s81, 12288
    s_nop 0
    buffer_load_dwordx4 v2, s[28:31], s39 offen lds
    buffer_load_dwordx4 v3, s[28:31], s39 offen offset:1024 lds
    v_mov_b32 v128, 0
    global_load_dword v27, v128, s[22:23] sc1
    s_waitcnt vmcnt(8) lgkmcnt(0)
    s_barrier
    ds_read_b128 a[32:35], v7 offset:8192
    ds_read_b128 a[36:39], v8 offset:8192
    ds_read_b128 a[40:43], v9 offset:8192
    ds_read_b128 a[44:47], v10 offset:8192
    s_add_u32 m0, s81, 16384
    s_nop 0
    buffer_load_dwordx4 v2, s[28:31], s68 offen lds
    buffer_load_dwordx4 v3, s[28:31], s68 offen offset:1024 lds
    s_waitcnt vmcnt(3) lgkmcnt(0)
    s_barrier
    ds_read_b128 a[48:51], v7 offset:12288
    ds_read_b128 a[52:55], v8 offset:12288
    ds_read_b128 a[56:59], v9 offset:12288
    ds_read_b128 a[60:63], v10 offset:12288
    s_add_u32 m0, s81, 20480
    s_nop 0
    buffer_load_dwordx4 v2, s[28:31], s69 offen lds
    buffer_load_dwordx4 v3, s[28:31], s69 offen offset:1024 lds
    s_waitcnt vmcnt(2) lgkmcnt(0)
    s_barrier
    ds_read_b128 a[64:67], v7 offset:16384
    ds_read_b128 a[68:71], v8 offset:16384
    ds_read_b128 a[72:75], v9 offset:16384
    ds_read_b128 a[76:79], v10 offset:16384
    s_add_u32 m0, s81, 24576
    s_nop 0
    buffer_load_dwordx4 v2, s[28:31], s70 offen lds
    buffer_load_dwordx4 v3, s[28:31], s70 offen offset:1024 lds
    s_waitcnt vmcnt(2) lgkmcnt(0)
    s_barrier
    ds_read_b128 a[80:83], v7 offset:20480
    ds_read_b128 a[84:87], v8 offset:20480
    ds_read_b128 a[88:91], v9 offset:20480
    ds_read_b128 a[92:95], v10 offset:20480
    s_add_u32 m0, s80, 0
    s_mul_i32 s92, s36, 1792
    buffer_load_dwordx4 v4, s[32:35], s92 offen lds
    buffer_load_dwordx4 v5, s[32:35], s92 offen offset:1024 lds
    s_add_u32 m0, s80, 4096
    s_mul_i32 s92, s37, 1792
    buffer_load_dwordx4 v4, s[32:35], s92 offen lds
    buffer_load_dwordx4 v5, s[32:35], s92 offen offset:1024 lds
    s_add_u32 m0, s80, 8192
    s_mul_i32 s92, s38, 1792
    buffer_load_dwordx4 v4, s[32:35], s92 offen lds
    buffer_load_dwordx4 v5, s[32:35], s92 offen offset:1024 lds
    s_waitcnt vmcnt(6) lgkmcnt(0)
    s_barrier
    ds_read_b128 a[96:99], v7 offset:24576
    ds_read_b128 a[100:103], v8 offset:24576
    ds_read_b128 a[104:107], v9 offset:24576
    ds_read_b128 a[108:111], v10 offset:24576
    v_cmp_eq_u32 vcc, 0, v27
    s_cbranch_vccz NRD_3
    s_mov_b32 s91, 0x40000
NR_2:
    global_load_dword v27, v128, s[22:23] sc1
    s_waitcnt vmcnt(0)
    v_cmp_eq_u32 vcc, 0, v27
    s_cbranch_vccz NRD_3
    s_sub_u32 s91, s91, 1
    s_cmp_eq_u32 s91, 0
    s_cbranch_scc1 NRD_3
    s_sleep 1
    s_branch NR_2
NRD_3:
    v_readfirstlane_b32 s22, v27
    s_nop 0
    s_mov_b32 s23, s22
    s_mov_b64 exec, 1
    buffer_store_dword v27, off, s[40:43], s21 sc1
    s_mov_b64 exec, -1
    s_add_u32 m0, s80, 12288
    s_mul_i32 s92, s39, 1792
    buffer_load_dwordx4 v4, s[32:35], s92 offen lds
    buffer_load_dwordx4 v5, s[32:35], s92 offen offset:1024 lds
    s_add_u32 m0, s80, 16384
    s_mul_i32 s92, s68, 1792
    buffer_load_dwordx4 v4, s[32:35], s92 offen lds
    buffer_load_dwordx4 v5, s[32:35], s92 offen offset:1024 lds
    s_add_u32 m0, s80, 20480
    s_mul_i32 s92, s69, 1792
    buffer_load_dwordx4 v4, s[32:35], s92 offen lds
    buffer_load_dwordx4 v5, s[32:35], s92 offen offset:1024 lds
    s_waitcnt vmcnt(7) lgkmcnt(0)
    s_barrier
    ds_read_b64_tr_b16 v[64:65], v13 offset:0
    ds_read_b64_tr_b16 v[66:67], v13 offset:512
    ds_read_b64_tr_b16 v[68:69], v14 offset:0
    ds_read_b64_tr_b16 v[70:71], v14 offset:512
    ds_read_b64_tr_b16 v[72:73], v13 offset:28672
    ds_read_b64_tr_b16 v[74:75], v13 offset:29184
    ds_read_b64_tr_b16 v[76:77], v14 offset:28672
    ds_read_b64_tr_b16 v[78:79], v14 offset:29184
    ds_read_b64_tr_b16 v[80:81], v15 offset:0
    ds_read_b64_tr_b16 v[82:83], v15 offset:512
    ds_read_b64_tr_b16 v[84:85], v16 offset:0
    ds_read_b64_tr_b16 v[86:87], v16 offset:512
    s_waitcnt lgkmcnt(8)
    v_mfma_f32_32x32x16_bf16 v[32:47], v[64:67], a[0:3], 0
    ds_read_b64_tr_b16 v[88:89], v15 offset:28672
    ds_read_b64_tr_b16 v[90:91], v15 offset:29184
    v_mfma_f32_32x32x16_bf16 v[48:63], v[68:71], a[0:3], 0
    ds_read_b64_tr_b16 v[92:93], v16 offset:28672
    ds_read_b64_tr_b16 v[94:95], v16 offset:29184
    s_add_u32 m0, s80, 24576
    s_mul_i32 s92, s70, 1792
    buffer_load_dwordx4 v4, s[32:35], s92 offen lds
    buffer_load_dwordx4 v5, s[32:35], s92 offen offset:1024 lds
    s_waitcnt lgkmcnt(8)
    v_mfma_f32_32x32x16_bf16 v[32:47], v[72:75], a[4:7], v[32:47]
    ds_read_b64_tr_b16 v[64:65], v13 offset:4096
    ds_read_b64_tr_b16 v[66:67], v13 offset:4608
    v_mfma_f32_32x32x16_bf16 v[48:63], v[76:79], a[4:7], v[48:63]
    ds_read_b64_tr_b16 v[68:69], v14 offset:4096
    ds_read_b64_tr_b16 v[70:71], v14 offset:4608
    s_and_b32 s89, s74, 1
    s_lshl_b32 s89, s89, 10
    s_add_u32 m0, s89, 26624
    v_add_u32 v136, s89, v1
    buffer_load_dwordx4 v136, s[64:67], 0 offen lds
    s_waitcnt lgkmcnt(8)
    v_mfma_f32_32x32x16_bf16 v[32:47], v[80:83], a[8:11], v[32:47]
    ds_read_b64_tr_b16 v[72:73], v13 offset:32768
    ds_read_b64_tr_b16 v[74:75], v13 offset:33280
    v_mfma_f32_32x32x16_bf16 v[48:63], v[84:87], a[8:11], v[48:63]
    ds_read_b64_tr_b16 v[76:77], v14 offset:32768
    ds_read_b64_tr_b16 v[78:79], v14 offset:33280
    s_waitcnt lgkmcnt(8)
    v_mfma_f32_32x32x16_bf16 v[32:47], v[88:91], a[12:15], v[32:47]
    ds_read_b64_tr_b16 v[80:81], v15 offset:4096
    ds_read_b64_tr_b16 v[82:83], v15 offset:4608
    v_mfma_f32_32x32x16_bf16 v[48:63], v[92:95], a[12:15], v[48:63]
    ds_read_b64_tr_b16 v[84:85], v16 offset:4096
    ds_read_b64_tr_b16 v[86:87], v16 offset:4608
    s_waitcnt lgkmcnt(8)
    v_mfma_f32_32x32x16_bf16 v[32:47], v[64:67], a[16:19], v[32:47]
    ds_read_b64_tr_b16 v[88:89], v15 offset:32768
    ds_read_b64_tr_b16 v[90:91], v15 offset:33280
    v_mfma_f32_32x32x16_bf16 v[48:63], v[68:71], a[16:19], v[48:63]
    ds_read_b64_tr_b16 v[92:93], v16 offset:32768
    ds_read_b64_tr_b16 v[94:95], v16 offset:33280
    s_waitcnt lgkmcnt(8)
    v_mfma_f32_32x32x16_bf16 v[32:47], v[72:75], a[20:23], v[32:47]
    ds_read_b64_tr_b16 v[64:65], v13 offset:8192
    ds_read_b64_tr_b16 v[66:67], v13 offset:8704
    v_mfma_f32_32x32x16_bf16 v[48:63], v[76:79], a[20:23], v[48:63]
    ds_read_b64_tr_b16 v[68:69], v14 offset:8192
    ds_read_b64_tr_b16 v[70:71], v14 offset:8704
    s_waitcnt lgkmcnt(8)
    v_mfma_f32_32x32x16_bf16 v[32:47], v[80:83], a[24:27], v[32:47]
    ds_read_b64_tr_b16 v[72:73], v13 offset:36864
    ds_read_b64_tr_b16 v[74:75], v13 offset:37376
    v_mfma_f32_32x32x16_bf16 v[48:63], v[84:87], a[24:27], v[48:63]
    ds_read_b64_tr_b16 v[76:77], v14 offset:36864
    ds_read_b64_tr_b16 v[78:79], v14 offset:37376
    s_waitcnt lgkmcnt(8)
    v_mfma_f32_32x32x16_bf16 v[32:47], v[88:91], a[28:31], v[32:47]
    ds_read_b64_tr_b16 v[80:81], v15 offset:8192
    ds_read_b64_tr_b16 v[82:83], v15 offset:8704
    v_mfma_f32_32x32x16_bf16 v[48:63], v[92:95], a[28:31], v[48:63]
    ds_read_b64_tr_b16 v[84:85], v16 offset:8192
    ds_read_b64_tr_b16 v[86:87], v16 offset:8704
    s_waitcnt lgkmcnt(8)
    v_mfma_f32_32x32x16_bf16 v[32:47], v[64:67], a[32:35], v[32:47]
    ds_read_b64_tr_b16 v[88:89], v15 offset:36864
    ds_read_b64_tr_b16 v[90:91], v15 offset:37376
    v_mfma_f32_32x32x16_bf16 v[48:63], v[68:71], a[32:35], v[48:63]
    ds_read_b64_tr_b16 v[92:93], v16 offset:36864
    ds_read_b64_tr_b16 v[94:95], v16 offset:37376
    s_waitcnt vmcnt(5)
    s_barrier
    s_waitcnt lgkmcnt(8)
    v_mfma_f32_32x32x16_bf16 v[32:47], v[72:75], a[36:39], v[32:47]
    ds_read_b64_tr_b16 v[64:65], v13 offset:12288
    ds_read_b64_tr_b16 v[66:67], v13 offset:12800
    v_mfma_f32_32x32x16_bf16 v[48:63], v[76:79], a[36:39], v[48:63]
    ds_read_b64_tr_b16 v[68:69], v14 offset:12288
    ds_read_b64_tr_b16 v[70:71], v14 offset:12800
    s_waitcnt lgkmcnt(8)
    v_mfma_f32_32x32x16_bf16 v[32:47], v[80:83], a[40:43], v[32:47]
    ds_read_b64_tr_b16 v[72:73], v13 offset:40960
    ds_read_b64_tr_b16 v[74:75], v13 offset:41472
    v_mfma_f32_32x32x16_bf16 v[48:63], v[84:87], a[40:43], v[48:63]
    ds_read_b64_tr_b16 v[76:77], v14 offset:40960
    ds_read_b64_tr_b16 v[78:79], v14 offset:41472
    s_waitcnt lgkmcnt(8)
    v_mfma_f32_32x32x16_bf16 v[32:47], v[88:91], a[44:47], v[32:47]
    ds_read_b64_tr_b16 v[80:81], v15 offset:12288
    ds_read_b64_tr_b16 v[82:83], v15 offset:12800
    v_mfma_f32_32x32x16_bf16 v[48:63], v[92:95], a[44:47], v[48:63]
    ds_read_b64_tr_b16 v[84:85], v16 offset:12288
    ds_read_b64_tr_b16 v[86:87], v16 offset:12800
    s_waitcnt lgkmcnt(8)
    v_mfma_f32_32x32x16_bf16 v[32:47], v[64:67], a[48:51], v[32:47]
    ds_read_b64_tr_b16 v[88:89], v15 offset:40960
    ds_read_b64_tr_b16 v[90:91], v15 offset:41472
    v_mfma_f32_32x32x16_bf16 v[48:63], v[68:71], a[48:51], v[48:63]
    ds_read_b64_tr_b16 v[92:93], v16 offset:40960
    ds_read_b64_tr_b16 v[94:95], v16 offset:41472
    s_waitcnt lgkmcnt(8)
    v_mfma_f32_32x32x16_bf16 v[32:47], v[72:75], a[52:55], v[32:47]
    ds_read_b64_tr_b16 v[64:65], v13 offset:16384
    ds_read_b64_tr_b16 v[66:67], v13 offset:16896
    v_mfma_f32_32x32x16_bf16 v[48:63], v[76:79], a[52:55], v[48:63]
    ds_read_b64_tr_b16 v[68:69], v14 offset:16384
    ds_read_b64_tr_b16 v[70:71], v14 offset:16896
    s_waitcnt lgkmcnt(8)
    v_mfma_f32_32x32x16_bf16 v[32:47], v[80:83], a[56:59], v[32:47]
    ds_read_b64_tr_b16 v[72:73], v13 offset:45056
    ds_read_b64_tr_b16 v[74:75], v13 offset:45568
    v_mfma_f32_32x32x16_bf16 v[48:63], v[84:87], a[56:59], v[48:63]
    ds_read_b64_tr_b16 v[76:77], v14 offset:45056
    ds_read_b64_tr_b16 v[78:79], v14 offset:45568
    s_waitcnt lgkmcnt(8)
    v_mfma_f32_32x32x16_bf16 v[32:47], v[88:91], a[60:63], v[32:47]
    ds_read_b64_tr_b16 v[80:81], v15 offset:16384
    ds_read_b64_tr_b16 v[82:83], v15 offset:16896
    v_mfma_f32_32x32x16_bf16 v[48:63], v[92:95], a[60:63], v[48:63]
    ds_read_b64_tr_b16 v[84:85], v16 offset:16384
    ds_read_b64_tr_b16 v[86:87], v16 offset:16896
    s_waitcnt lgkmcnt(8)
    v_mfma_f32_32x32x16_bf16 v[32:47], v[64:67], a[64:67], v[32:47]
    ds_read_b64_tr_b16 v[88:89], v15 offset:45056
    ds_read_b64_tr_b16 v[90:91], v15 offset:45568
    v_mfma_f32_32x32x16_bf16 v[48:63], v[68:71], a[64:67], v[48:63]
    ds_read_b64_tr_b16 v[92:93], v16 offset:45056
    ds_read_b64_tr_b16 v[94:95], v16 offset:45568
    s_waitcnt vmcnt(1)
    s_barrier
    s_waitcnt lgkmcnt(8)
    v_mfma_f32_32x32x16_bf16 v[32:47], v[72:75], a[68:71], v[32:47]
    ds_read_b64_tr_b16 v[64:65], v13 offset:20480
    ds_read_b64_tr_b16 v[66:67], v13 offset:20992
    v_mfma_f32_32x32x16_bf16 v[48:63], v[76:79], a[68:71], v[48:63]
    ds_read_b64_tr_b16 v[68:69], v14 offset:20480
    ds_read_b64_tr_b16 v[70:71], v14 offset:20992
    s_waitcnt lgkmcnt(8)
    v_mfma_f32_32x32x16_bf16 v[32:47], v[80:83], a[72:75], v[32:47]
    ds_read_b64_tr_b16 v[72:73], v13 offset:49152
    ds_read_b64_tr_b16 v[74:75], v13 offset:49664
    v_mfma_f32_32x32x16_bf16 v[48:63], v[84:87], a[72:75], v[48:63]
    ds_read_b64_tr_b16 v[76:77], v14 offset:49152
    ds_read_b64_tr_b16 v[78:79], v14 offset:49664
    s_waitcnt lgkmcnt(8)
    v_mfma_f32_32x32x16_bf16 v[32:47], v[88:91], a[76:79], v[32:47]
    ds_read_b64_tr_b16 v[80:81], v15 offset:20480
    ds_read_b64_tr_b16 v[82:83], v15 offset:20992
    v_mfma_f32_32x32x16_bf16 v[48:63], v[92:95], a[76:79], v[48:63]
    ds_read_b64_tr_b16 v[84:85], v16 offset:20480
    ds_read_b64_tr_b16 v[86:87], v16 offset:20992
    s_waitcnt lgkmcnt(8)
    v_mfma_f32_32x32x16_bf16 v[32:47], v[64:67], a[80:83], v[32:47]
    ds_read_b64_tr_b16 v[88:89], v15 offset:49152
    ds_read_b64_tr_b16 v[90:91], v15 offset:49664
    v_mfma_f32_32x32x16_bf16 v[48:63], v[68:71], a[80:83], v[48:63]
    ds_read_b64_tr_b16 v[92:93], v16 offset:49152
    ds_read_b64_tr_b16 v[94:95], v16 offset:49664
    s_waitcnt lgkmcnt(8)
    v_mfma_f32_32x32x16_bf16 v[32:47], v[72:75], a[84:87], v[32:47]
    ds_read_b64_tr_b16 v[64:65], v13 offset:24576
    ds_read_b64_tr_b16 v[66:67], v13 offset:25088
    v_mfma_f32_32x32x16_bf16 v[48:63], v[76:79], a[84:87], v[48:63]
    ds_read_b64_tr_b16 v[68:69], v14 offset:24576
    ds_read_b64_tr_b16 v[70:71], v14 offset:25088
    s_waitcnt lgkmcnt(8)
    v_mfma_f32_32x32x16_bf16 v[32:47], v[80:83], a[88:91], v[32:47]
    ds_read_b64_tr_b16 v[72:73], v13 offset:53248
    ds_read_b64_tr_b16 v[74:75], v13 offset:53760
    v_mfma_f32_32x32x16_bf16 v[48:63], v[84:87], a[88:91], v[48:63]
    ds_read_b64_tr_b16 v[76:77], v14 offset:53248
    ds_read_b64_tr_b16 v[78:79], v14 offset:53760
    s_waitcnt lgkmcnt(8)
    v_mfma_f32_32x32x16_bf16 v[32:47], v[88:91], a[92:95], v[32:47]
    ds_read_b64_tr_b16 v[80:81], v15 offset:24576
    ds_read_b64_tr_b16 v[82:83], v15 offset:25088
    v_mfma_f32_32x32x16_bf16 v[48:63], v[92:95], a[92:95], v[48:63]
    ds_read_b64_tr_b16 v[84:85], v16 offset:24576
    ds_read_b64_tr_b16 v[86:87], v16 offset:25088
    s_waitcnt lgkmcnt(8)
    v_mfma_f32_32x32x16_bf16 v[32:47], v[64:67], a[96:99], v[32:47]
    ds_read_b64_tr_b16 v[88:89], v15 offset:53248
    ds_read_b64_tr_b16 v[90:91], v15 offset:53760
    v_mfma_f32_32x32x16_bf16 v[48:63], v[68:71], a[96:99], v[48:63]
    ds_read_b64_tr_b16 v[92:93], v16 offset:53248
    ds_read_b64_tr_b16 v[94:95], v16 offset:53760
    s_waitcnt lgkmcnt(8)
    v_mfma_f32_32x32x16_bf16 v[32:47], v[72:75], a[100:103], v[32:47]
    v_mfma_f32_32x32x16_bf16 v[48:63], v[76:79], a[100:103], v[48:63]
    s_waitcnt lgkmcnt(4)
    v_mfma_f32_32x32x16_bf16 v[32:47], v[80:83], a[104:107], v[32:47]
    v_mfma_f32_32x32x16_bf16 v[48:63], v[84:87], a[104:107], v[48:63]
    s_waitcnt lgkmcnt(0)
    v_mfma_f32_32x32x16_bf16 v[32:47], v[88:91], a[108:111], v[32:47]
    v_mfma_f32_32x32x16_bf16 v[48:63], v[92:95], a[108:111], v[48:63]
    s_add_u32 s88, s95, 1572864
    buffer_load_dword v137, v141, s[40:43], s88 offen sc1
    s_waitcnt vmcnt(0)
    v_cmp_ne_u32 vcc, v27, v137
    s_cbranch_vccz POLLD_5
    s_add_u32 s88, s95, 1572864
    s_mov_b32 s91, 0x40000
POLL_4:
    buffer_load_dword v137, v141, s[40:43], s88 offen sc1
    s_waitcnt vmcnt(0)
    v_cmp_ne_u32 vcc, v27, v137
    s_cbranch_vccz POLLD_5
    s_sub_u32 s91, s91, 1
    s_cmp_eq_u32 s91, 0
    s_cbranch_scc1 POLLD_5
    s_sleep 1
    s_branch POLL_4
POLLD_5:
    s_add_u32 m0, s93, 0
    s_lshl_b32 s92, s36, 5
    s_add_u32 s92, s92, s83
    buffer_load_dwordx4 v1, s[40:43], s92 offen sc1 lds
    s_add_u32 m0, s93, 28672
    s_add_u32 s92, s92, 458752
    buffer_load_dwordx4 v1, s[40:43], s92 offen sc1 lds
    s_add_u32 m0, s93, 4096
    s_lshl_b32 s92, s37, 5
    s_add_u32 s92, s92, s83
    buffer_load_dwordx4 v1, s[40:43], s92 offen sc1 lds
    s_add_u32 m0, s93, 32768
    s_add_u32 s92, s92, 458752
    buffer_load_dwordx4 v1, s[40:43], s92 offen sc1 lds
    s_add_u32 m0, s93, 8192
    s_lshl_b32 s92, s38, 5
    s_add_u32 s92, s92, s83
    buffer_load_dwordx4 v1, s[40:43], s92 offen sc1 lds
    s_add_u32 m0, s93, 36864
    s_add_u32 s92, s92, 458752
    buffer_load_dwordx4 v1, s[40:43], s92 offen sc1 lds
    s_add_u32 m0, s93, 12288
    s_lshl_b32 s92, s39, 5
    s_add_u32 s92, s92, s83
    buffer_load_dwordx4 v1, s[40:43], s92 offen sc1 lds
    s_add_u32 m0, s93, 40960
    s_add_u32 s92, s92, 458752
    buffer_load_dwordx4 v1, s[40:43], s92 offen sc1 lds
    s_add_u32 m0, s93, 16384
    s_lshl_b32 s92, s68, 5
    s_add_u32 s92, s92, s83
    buffer_load_dwordx4 v1, s[40:43], s92 offen sc1 lds
    s_add_u32 m0, s93, 45056
    s_add_u32 s92, s92, 458752
    buffer_load_dwordx4 v1, s[40:43], s92 offen sc1 lds
    s_add_u32 m0, s93, 20480
    s_lshl_b32 s92, s69, 5
    s_add_u32 s92, s92, s83
    buffer_load_dwordx4 v1, s[40:43], s92 offen sc1 lds
    s_add_u32 m0, s80, 6144
    s_add_u32 s92, s92, 458752
    buffer_load_dwordx4 v1, s[40:43], s92 offen sc1 lds
    s_add_u32 m0, s93, 24576
    s_lshl_b32 s92, s70, 5
    s_add_u32 s92, s92, s83
    buffer_load_dwordx4 v1, s[40:43], s92 offen sc1 lds
    s_add_u32 m0, s80, 7168
    s_add_u32 s92, s92, 458752
    buffer_load_dwordx4 v1, s[40:43], s92 offen sc1 lds
    s_add_u32 m0, s80, 10240
    s_lshl_b32 s92, s36, 5
    s_add_u32 s92, s92, s94
    buffer_load_dwordx4 v1, s[40:43], s92 offen sc1 lds
    s_add_u32 m0, s80, 11264
    s_lshl_b32 s92, s37, 5
    s_add_u32 s92, s92, s94
    buffer_load_dwordx4 v1, s[40:43], s92 offen sc1 lds
    s_add_u32 m0, s80, 14336
    s_lshl_b32 s92, s38, 5
    s_add_u32 s92, s92, s94
    buffer_load_dwordx4 v1, s[40:43], s92 offen sc1 lds
    s_add_u32 m0, s80, 15360
    s_lshl_b32 s92, s39, 5
    s_add_u32 s92, s92, s94
    buffer_load_dwordx4 v1, s[40:43], s92 offen sc1 lds
    s_add_u32 m0, s80, 18432
    s_lshl_b32 s92, s68, 5
    s_add_u32 s92, s92, s94
    buffer_load_dwordx4 v1, s[40:43], s92 offen sc1 lds
    s_add_u32 m0, s80, 19456
    s_lshl_b32 s92, s69, 5
    s_add_u32 s92, s92, s94
    buffer_load_dwordx4 v1, s[40:43], s92 offen sc1 lds
    s_add_u32 m0, s80, 22528
    s_lshl_b32 s92, s70, 5
    s_add_u32 s92, s92, s94
    buffer_load_dwordx4 v1, s[40:43], s92 offen sc1 lds
    v_mul_f32 v104, s27, v32
    v_mul_f32 v105, s27, v33
    v_mul_f32 v106, s27, v34
    v_mul_f32 v107, s27, v35
    v_exp_f32 v104, v104
    v_exp_f32 v105, v105
    v_exp_f32 v106, v106
    v_exp_f32 v107, v107
    v_add_f32 v104, 1.0, v104
    v_add_f32 v105, 1.0, v105
    v_add_f32 v106, 1.0, v106
    v_add_f32 v107, 1.0, v107
    v_rcp_f32 v104, v104
    v_rcp_f32 v105, v105
    v_rcp_f32 v106, v106
    v_rcp_f32 v107, v107
    v_mul_f32 v104, v32, v104
    v_mul_f32 v105, v33, v105
    v_mul_f32 v106, v34, v106
    v_mul_f32 v107, v35, v107
    v_cvt_pk_bf16_f32 v120, v104, v105
    v_cvt_pk_bf16_f32 v121, v106, v107
    v_mul_f32 v108, s27, v36
    v_mul_f32 v109, s27, v37
    v_mul_f32 v110, s27, v38
    v_mul_f32 v111, s27, v39
    v_exp_f32 v108, v108
    v_exp_f32 v109, v109
    v_exp_f32 v110, v110
    v_exp_f32 v111, v111
    v_add_f32 v108, 1.0, v108
    v_add_f32 v109, 1.0, v109
    v_add_f32 v110, 1.0, v110
    v_add_f32 v111, 1.0, v111
    v_rcp_f32 v108, v108
    v_rcp_f32 v109, v109
    v_rcp_f32 v110, v110
    v_rcp_f32 v111, v111
    v_mul_f32 v108, v36, v108
    v_mul_f32 v109, v37, v109
    v_mul_f32 v110, v38, v110
    v_mul_f32 v111, v39, v111
    v_cvt_pk_bf16_f32 v122, v108, v109
    v_cvt_pk_bf16_f32 v123, v110, v111
    buffer_store_dwordx4 v[120:123], v1, s[44:47], s84 offen offset:0 sc1
    v_mul_f32 v112, s27, v40
    v_mul_f32 v113, s27, v41
    v_mul_f32 v114, s27, v42
    v_mul_f32 v115, s27, v43
    v_exp_f32 v112, v112
    v_exp_f32 v113, v113
    v_exp_f32 v114, v114
    v_exp_f32 v115, v115
    v_add_f32 v112, 1.0, v112
    v_add_f32 v113, 1.0, v113
    v_add_f32 v114, 1.0, v114
    v_add_f32 v115, 1.0, v115
    v_rcp_f32 v112, v112
    v_rcp_f32 v113, v113
    v_rcp_f32 v114, v114
    v_rcp_f32 v115, v115
    v_mul_f32 v112, v40, v112
    v_mul_f32 v113, v41, v113
    v_mul_f32 v114, v42, v114
    v_mul_f32 v115, v43, v115
    v_cvt_pk_bf16_f32 v124, v112, v113
    v_cvt_pk_bf16_f32 v125, v114, v115
    v_mul_f32 v116, s27, v44
    v_mul_f32 v117, s27, v45
    v_mul_f32 v118, s27, v46
    v_mul_f32 v119, s27, v47
    v_exp_f32 v116, v116
    v_exp_f32 v117, v117
    v_exp_f32 v118, v118
    v_exp_f32 v119, v119
    v_add_f32 v116, 1.0, v116
    v_add_f32 v117, 1.0, v117
    v_add_f32 v118, 1.0, v118
    v_add_f32 v119, 1.0, v119
    v_rcp_f32 v116, v116
    v_rcp_f32 v117, v117
    v_rcp_f32 v118, v118
    v_rcp_f32 v119, v119
    v_mul_f32 v116, v44, v116
    v_mul_f32 v117, v45, v117
    v_mul_f32 v118, v46, v118
    v_mul_f32 v119, v47, v119
    v_cvt_pk_bf16_f32 v126, v116, v117
    v_cvt_pk_bf16_f32 v127, v118, v119
    buffer_store_dwordx4 v[124:127], v1, s[44:47], s84 offen offset:1024 sc1
    v_mul_f32 v104, s27, v48
    v_mul_f32 v105, s27, v49
    v_mul_f32 v106, s27, v50
    v_mul_f32 v107, s27, v51
    v_exp_f32 v104, v104
    v_exp_f32 v105, v105
    v_exp_f32 v106, v106
    v_exp_f32 v107, v107
    v_add_f32 v104, 1.0, v104
    v_add_f32 v105, 1.0, v105
    v_add_f32 v106, 1.0, v106
    v_add_f32 v107, 1.0, v107
    v_rcp_f32 v104, v104
    v_rcp_f32 v105, v105
    v_rcp_f32 v106, v106
    v_rcp_f32 v107, v107
    v_mul_f32 v104, v48, v104
    v_mul_f32 v105, v49, v105
    v_mul_f32 v106, v50, v106
    v_mul_f32 v107, v51, v107
    v_cvt_pk_bf16_f32 v120, v104, v105
    v_cvt_pk_bf16_f32 v121, v106, v107
    v_mul_f32 v108, s27, v52
    v_mul_f32 v109, s27, v53
    v_mul_f32 v110, s27, v54
    v_mul_f32 v111, s27, v55
    v_exp_f32 v108, v108
    v_exp_f32 v109, v109
    v_exp_f32 v110, v110
    v_exp_f32 v111, v111
    v_add_f32 v108, 1.0, v108
    v_add_f32 v109, 1.0, v109
    v_add_f32 v110, 1.0, v110
    v_add_f32 v111, 1.0, v111
    v_rcp_f32 v108, v108
    v_rcp_f32 v109, v109
    v_rcp_f32 v110, v110
    v_rcp_f32 v111, v111
    v_mul_f32 v108, v52, v108
    v_mul_f32 v109, v53, v109
    v_mul_f32 v110, v54, v110
    v_mul_f32 v111, v55, v111
    v_cvt_pk_bf16_f32 v122, v108, v109
    v_cvt_pk_bf16_f32 v123, v110, v111
    buffer_store_dwordx4 v[120:123], v1, s[44:47], s84 offen offset:2048 sc1
    v_mul_f32 v112, s27, v56
    v_mul_f32 v113, s27, v57
    v_mul_f32 v114, s27, v58
    v_mul_f32 v115, s27, v59
    v_exp_f32 v112, v112
    v_exp_f32 v113, v113
    v_exp_f32 v114, v114
    v_exp_f32 v115, v115
    v_add_f32 v112, 1.0, v112
    v_add_f32 v113, 1.0, v113
    v_add_f32 v114, 1.0, v114
    v_add_f32 v115, 1.0, v115
    v_rcp_f32 v112, v112
    v_rcp_f32 v113, v113
    v_rcp_f32 v114, v114
    v_rcp_f32 v115, v115
    v_mul_f32 v112, v56, v112
    v_mul_f32 v113, v57, v113
    v_mul_f32 v114, v58, v114
    v_mul_f32 v115, v59, v115
    v_cvt_pk_bf16_f32 v124, v112, v113
    v_cvt_pk_bf16_f32 v125, v114, v115
    v_mul_f32 v116, s27, v60
    v_mul_f32 v117, s27, v61
    v_mul_f32 v118, s27, v62
    v_mul_f32 v119, s27, v63
    v_exp_f32 v116, v116
    v_exp_f32 v117, v117
    v_exp_f32 v118, v118
    v_exp_f32 v119, v119
    v_add_f32 v116, 1.0, v116
    v_add_f32 v117, 1.0, v117
    v_add_f32 v118, 1.0, v118
    v_add_f32 v119, 1.0, v119
    v_rcp_f32 v116, v116
    v_rcp_f32 v117, v117
    v_rcp_f32 v118, v118
    v_rcp_f32 v119, v119
    v_mul_f32 v116, v60, v116
    v_mul_f32 v117, v61, v117
    v_mul_f32 v118, v62, v118
    v_mul_f32 v119, v63, v119
    v_cvt_pk_bf16_f32 v126, v116, v117
    v_cvt_pk_bf16_f32 v127, v118, v119
    buffer_store_dwordx4 v[124:127], v1, s[44:47], s84 offen offset:3072 sc1
    s_waitcnt vmcnt(4) lgkmcnt(0)
    s_barrier
    ds_read_b64_tr_b16 v[64:65], v17 offset:0
    ds_read_b64_tr_b16 v[66:67], v17 offset:256
    ds_read_b64_tr_b16 v[68:69], v17 offset:1024
    ds_read_b64_tr_b16 v[70:71], v17 offset:1280
    ds_read_b64_tr_b16 v[72:73], v17 offset:2048
    ds_read_b64_tr_b16 v[74:75], v17 offset:2304
    ds_read_b64_tr_b16 v[76:77], v17 offset:3072
    ds_read_b64_tr_b16 v[78:79], v17 offset:3328
    s_waitcnt lgkmcnt(4)
    v_mfma_f32_32x32x16_bf16 v[88:103], v[64:67], a[0:3], 0
    ds_read_b64_tr_b16 v[80:81], v17 offset:4096
    ds_read_b64_tr_b16 v[82:83], v17 offset:4352
    v_mfma_f32_32x32x16_bf16 v[88:103], v[68:71], a[4:7], v[88:103]
    ds_read_b64_tr_b16 v[84:85], v17 offset:5120
    ds_read_b64_tr_b16 v[86:87], v17 offset:5376
    s_waitcnt lgkmcnt(4)
    v_mfma_f32_32x32x16_bf16 v[88:103], v[72:75], a[8:11], v[88:103]
    ds_read_b64_tr_b16 v[64:65], v17 offset:6144
    ds_read_b64_tr_b16 v[66:67], v17 offset:6400
    v_mfma_f32_32x32x16_bf16 v[88:103], v[76:79], a[12:15], v[88:103]
    ds_read_b64_tr_b16 v[68:69], v17 offset:7168
    ds_read_b64_tr_b16 v[70:71], v17 offset:7424
    s_waitcnt lgkmcnt(4)
    v_mfma_f32_32x32x16_bf16 v[88:103], v[80:83], a[16:19], v[88:103]
    ds_read_b64_tr_b16 v[72:73], v17 offset:8192
    ds_read_b64_tr_b16 v[74:75], v17 offset:8448
    v_mfma_f32_32x32x16_bf16 v[88:103], v[84:87], a[20:23], v[88:103]
    ds_read_b64_tr_b16 v[76:77], v17 offset:9216
    ds_read_b64_tr_b16 v[78:79], v17 offset:9472
    s_waitcnt lgkmcnt(4)
    v_mfma_f32_32x32x16_bf16 v[88:103], v[64:67], a[24:27], v[88:103]
    ds_read_b64_tr_b16 v[80:81], v17 offset:10240
    ds_read_b64_tr_b16 v[82:83], v17 offset:10496
    v_mfma_f32_32x32x16_bf16 v[88:103], v[68:71], a[28:31], v[88:103]
    ds_read_b64_tr_b16 v[84:85], v17 offset:11264
    ds_read_b64_tr_b16 v[86:87], v17 offset:11520
    s_waitcnt lgkmcnt(4)
    v_mfma_f32_32x32x16_bf16 v[88:103], v[72:75], a[32:35], v[88:103]
    ds_read_b64_tr_b16 v[64:65], v17 offset:12288
    ds_read_b64_tr_b16 v[66:67], v17 offset:12544
    v_mfma_f32_32x32x16_bf16 v[88:103], v[76:79], a[36:39], v[88:103]
    ds_read_b64_tr_b16 v[68:69], v17 offset:13312
    ds_read_b64_tr_b16 v[70:71], v17 offset:13568
    s_waitcnt lgkmcnt(4)
    v_mfma_f32_32x32x16_bf16 v[88:103], v[80:83], a[40:43], v[88:103]
    ds_read_b64_tr_b16 v[72:73], v17 offset:14336
    ds_read_b64_tr_b16 v[74:75], v17 offset:14592
    v_mfma_f32_32x32x16_bf16 v[88:103], v[84:87], a[44:47], v[88:103]
    ds_read_b64_tr_b16 v[76:77], v17 offset:15360
    ds_read_b64_tr_b16 v[78:79], v17 offset:15616
    s_waitcnt lgkmcnt(4)
    v_mfma_f32_32x32x16_bf16 v[88:103], v[64:67], a[48:51], v[88:103]
    ds_read_b64_tr_b16 v[80:81], v17 offset:16384
    ds_read_b64_tr_b16 v[82:83], v17 offset:16640
    v_mfma_f32_32x32x16_bf16 v[88:103], v[68:71], a[52:55], v[88:103]
    ds_read_b64_tr_b16 v[84:85], v17 offset:17408
    ds_read_b64_tr_b16 v[86:87], v17 offset:17664
    s_waitcnt lgkmcnt(4)
    v_mfma_f32_32x32x16_bf16 v[88:103], v[72:75], a[56:59], v[88:103]
    ds_read_b64_tr_b16 v[64:65], v17 offset:18432
    ds_read_b64_tr_b16 v[66:67], v17 offset:18688
    v_mfma_f32_32x32x16_bf16 v[88:103], v[76:79], a[60:63], v[88:103]
    ds_read_b64_tr_b16 v[68:69], v17 offset:19456
    ds_read_b64_tr_b16 v[70:71], v17 offset:19712
    s_waitcnt lgkmcnt(4)
    v_mfma_f32_32x32x16_bf16 v[88:103], v[80:83], a[64:67], v[88:103]
    ds_read_b64_tr_b16 v[72:73], v17 offset:20480
    ds_read_b64_tr_b16 v[74:75], v17 offset:20736
    v_mfma_f32_32x32x16_bf16 v[88:103], v[84:87], a[68:71], v[88:103]
    ds_read_b64_tr_b16 v[76:77], v17 offset:21504
    ds_read_b64_tr_b16 v[78:79], v17 offset:21760
    s_waitcnt lgkmcnt(4)
    v_mfma_f32_32x32x16_bf16 v[88:103], v[64:67], a[72:75], v[88:103]
    ds_read_b64_tr_b16 v[80:81], v17 offset:22528
    ds_read_b64_tr_b16 v[82:83], v17 offset:22784
    v_mfma_f32_32x32x16_bf16 v[88:103], v[68:71], a[76:79], v[88:103]
    ds_read_b64_tr_b16 v[84:85], v17 offset:23552
    ds_read_b64_tr_b16 v[86:87], v17 offset:23808
    s_waitcnt lgkmcnt(4)
    v_mfma_f32_32x32x16_bf16 v[88:103], v[72:75], a[80:83], v[88:103]
    ds_read_b64_tr_b16 v[64:65], v17 offset:24576
    ds_read_b64_tr_b16 v[66:67], v17 offset:24832
    v_mfma_f32_32x32x16_bf16 v[88:103], v[76:79], a[84:87], v[88:103]
    ds_read_b64_tr_b16 v[68:69], v17 offset:25600
    ds_read_b64_tr_b16 v[70:71], v17 offset:25856
    s_waitcnt lgkmcnt(4)
    v_mfma_f32_32x32x16_bf16 v[88:103], v[80:83], a[88:91], v[88:103]
    ds_read_b64_tr_b16 v[72:73], v17 offset:26624
    ds_read_b64_tr_b16 v[74:75], v17 offset:26880
    v_mfma_f32_32x32x16_bf16 v[88:103], v[84:87], a[92:95], v[88:103]
    ds_read_b64_tr_b16 v[76:77], v17 offset:27648
    ds_read_b64_tr_b16 v[78:79], v17 offset:27904
    s_waitcnt lgkmcnt(4)
    v_mfma_f32_32x32x16_bf16 v[88:103], v[64:67], a[96:99], v[88:103]
    v_mfma_f32_32x32x16_bf16 v[88:103], v[68:71], a[100:103], v[88:103]
    s_waitcnt lgkmcnt(0)
    v_mfma_f32_32x32x16_bf16 v[88:103], v[72:75], a[104:107], v[88:103]
    v_mfma_f32_32x32x16_bf16 v[88:103], v[76:79], a[108:111], v[88:103]
    s_lshl2_add_u32 s89, s72, s78
    s_lshl4_add_u32 s89, s89, s73
    s_lshl_b32 s89, s89, 7
    s_lshl_b32 s87, s79, 17
    s_add_u32 s64, s89, s87
    s_add_u32 s64, s64, 1703936
    s_add_u32 s87, s77, s79
    s_lshl_b32 s65, s87, 11
    s_lshl_b32 s87, s78, 3
    s_cmp_lt_u32 s78, 3
    s_cselect_b32 s87, s87, 24
    s_mul_i32 s36, s87, 57344
    s_cselect_b32 s37, 2, 1
    s_lshl_b32 s67, s37, 12
    s_mul_i32 s37, s37, 57344
    s_mul_i32 s38, s78, 344064
    s_add_u32 s38, s38, 57344
    s_add_u32 s92, s77, s79
    s_mul_i32 s28, s92, 147456
    s_add_u32 s28, s28, 4194304
    s_lshl_b32 s87, s87, 12
    s_add_u32 s39, s28, s87
    s_mul_i32 s87, s78, 24576
    s_add_u32 s68, s28, s87
    s_add_u32 s68, s68, 4096
    s_lshl_b32 s87, s78, 13
    s_add_u32 s29, s28, s87
    s_add_u32 s29, s29, 114688
    s_mul_i32 s30, s78, 100352
    s_mul_i32 s35, s78, 12288
    s_add_u32 s35, s35, 114688
    s_add_u32 s87, s72, s76
    s_and_b32 s87, s87, 3
    s_lshl_b32 s87, s87, 2
    s_lshr_b32 s33, 0x32103210, s87
    s_lshr_b32 s34, 0x210210, s87
    s_add_u32 s88, s65, 1835008
    buffer_load_dword v137, v26, s[40:43], s88 offen sc1
    s_waitcnt lgkmcnt(0)
    s_barrier
    ds_read_b64_tr_b16 v[128:129], v139 offset:0
    ds_read_b64_tr_b16 v[130:131], v139 offset:448
    ds_read_b64_tr_b16 v[132:133], v139 offset:896
    ds_read_b64_tr_b16 v[134:135], v139 offset:1344
    s_add_u32 m0, s35, 0
    s_bfe_u32 s92, s34, 262148
    s_mul_i32 s92, s92, 114688
    s_add_u32 s92, s92, s38
    buffer_load_dwordx4 v6, s[52:55], s92 offen lds
    buffer_load_dwordx4 v140, s[52:55], s92 offen offset:1024 lds
    s_waitcnt lgkmcnt(0)
    v_cvt_pk_bf16_f32 v104, v88, v89
    v_cvt_pk_bf16_f32 v105, v90, v91
    v_cvt_pk_bf16_f32 v106, v92, v93
    v_cvt_pk_bf16_f32 v107, v94, v95
    v_cvt_pk_bf16_f32 v108, v96, v97
    v_cvt_pk_bf16_f32 v109, v98, v99
    v_cvt_pk_bf16_f32 v110, v100, v101
    v_cvt_pk_bf16_f32 v111, v102, v103
    v_mfma_f32_32x32x16_bf16 v[64:79], v[128:131], v[104:107], 0
    s_nop 0
    v_mfma_f32_32x32x16_bf16 v[64:79], v[132:135], v[108:111], v[64:79]
    s_nop 11
    v_cndmask_b32 v80, v76, v64, s[96:97]
    v_cndmask_b32 v81, v77, v64, s[96:97]
    v_cndmask_b32 v82, v78, v64, s[96:97]
    v_cndmask_b32 v83, v79, v64, s[96:97]
    v_max3_f32 v84, v64, v65, v66
    v_min3_f32 v85, v64, v65, v66
    v_max3_f32 v84, v84, v67, v68
    v_min3_f32 v85, v85, v67, v68
    v_max3_f32 v84, v84, v69, v70
    v_min3_f32 v85, v85, v69, v70
    v_max3_f32 v84, v84, v71, v72
    v_min3_f32 v85, v85, v71, v72
    v_max3_f32 v84, v84, v73, v74
    v_min3_f32 v85, v85, v73, v74
    v_max3_f32 v84, v84, v75, v80
    v_min3_f32 v85, v85, v75, v80
    v_max3_f32 v84, v84, v81, v82
    v_min3_f32 v85, v85, v81, v82
    v_max_f32 v84, v84, v83
    v_min_f32 v85, v85, v83
    v_mov_b32 v86, v84
    v_mov_b32 v87, v85
    s_nop 0
    v_permlane32_swap_b32 v84, v86
    v_permlane32_swap_b32 v85, v87
    v_max_f32 v84, v84, v86
    v_min_f32 v85, v85, v87
    v_mul_f32 v80, s27, v84
    v_mul_f32 v81, s90, v85
    v_mov_b32 v86, 0xff800000
    v_cndmask_b32 v83, v81, v86, s[96:97]
    v_cndmask_b32 v82, v80, v86, s[96:97]
    v_fma_f32 v112, v64, s90, v80
    v_fma_f32 v113, v65, s90, v80
    v_fma_f32 v114, v66, s90, v80
    v_fma_f32 v115, v67, s90, v80
    v_exp_f32 v112, v112
    v_exp_f32 v113, v113
    v_exp_f32 v114, v114
    v_exp_f32 v115, v115
    v_fma_f32 v116, v68, s90, v80
    s_waitcnt vmcnt(2)
    v_cmp_ne_u32 vcc, v27, v137
    s_cbranch_vccz POLLD_7
    s_add_u32 s88, s65, 1835008
    s_mov_b32 s91, 0x40000
POLL_6:
    buffer_load_dword v137, v26, s[40:43], s88 offen sc1
    s_waitcnt vmcnt(0)
    v_cmp_ne_u32 vcc, v27, v137
    s_cbranch_vccz POLLD_7
    s_sub_u32 s91, s91, 1
    s_cmp_eq_u32 s91, 0
    s_cbranch_scc1 POLLD_7
    s_sleep 1
    s_branch POLL_6
POLLD_7:
    v_fma_f32 v117, v69, s90, v80
    s_add_u32 m0, s35, 4096
    s_bfe_u32 s92, s34, 262148
    s_mul_i32 s92, s92, 114688
    s_add_u32 s92, s92, s38
    s_add_u32 s92, s92, 28672
    buffer_load_dwordx4 v6, s[52:55], s92 offen lds
    buffer_load_dwordx4 v140, s[52:55], s92 offen offset:1024 lds
    v_fma_f32 v118, v70, s90, v80
    v_fma_f32 v119, v71, s90, v80
    v_exp_f32 v116, v116
    v_exp_f32 v117, v117
    v_exp_f32 v118, v118
    v_exp_f32 v119, v119
    v_fma_f32 v120, v72, s90, v80
    v_fma_f32 v121, v73, s90, v80
    v_fma_f32 v122, v74, s90, v80
    v_fma_f32 v123, v75, s90, v80
    v_exp_f32 v120, v120
    v_exp_f32 v121, v121
    v_exp_f32 v122, v122
    v_exp_f32 v123, v123
    v_fma_f32 v124, v76, s90, v82
    v_fma_f32 v125, v77, s90, v82
    v_fma_f32 v126, v78, s90, v82
    v_fma_f32 v127, v79, s90, v82
    v_exp_f32 v124, v124
    v_exp_f32 v125, v125
    s_add_u32 m0, s35, 8192
    s_bfe_u32 s92, s34, 262152
    s_mul_i32 s92, s92, 114688
    s_add_u32 s92, s92, s38
    buffer_load_dwordx4 v6, s[52:55], s92 offen lds
    buffer_load_dwordx4 v140, s[52:55], s92 offen offset:1024 lds
    v_exp_f32 v126, v126
    v_exp_f32 v127, v127
    v_add_f32 v84, v112, v113
    v_add_f32 v87, v114, v115
    v_add_f32 v84, v84, v116
    v_add_f32 v87, v87, v117
    v_add_f32 v84, v84, v118
    v_add_f32 v87, v87, v119
    v_add_f32 v84, v84, v120
    v_add_f32 v87, v87, v121
    v_add_f32 v84, v84, v122
    v_add_f32 v87, v87, v123
    v_add_f32 v84, v84, v124
    v_add_f32 v87, v87, v125
    v_add_f32 v84, v84, v126
    v_add_f32 v87, v87, v127
    v_add_f32 v84, v84, v87
    v_mov_b32 v87, v84
    s_nop 1
    v_permlane32_swap_b32 v84, v87
    v_add_f32 v84, v84, v87
    v_rcp_f32 v84, v84
    s_nop 0
    v_mul_f32 v112, v112, v84
    v_mul_f32 v113, v113, v84
    s_add_u32 m0, s80, 6144
    s_bfe_u32 s92, s34, 262152
    s_mul_i32 s92, s92, 114688
    s_add_u32 s92, s92, s38
    s_add_u32 s92, s92, 28672
    buffer_load_dwordx4 v6, s[52:55], s92 offen lds
    buffer_load_dwordx4 v140, s[52:55], s92 offen offset:1024 lds
    v_cvt_pk_bf16_f32 v88, v112, v113
    v_mul_f32 v114, v114, v84
    v_mul_f32 v115, v115, v84
    v_cvt_pk_bf16_f32 v89, v114, v115
    v_mul_f32 v116, v116, v84
    v_mul_f32 v117, v117, v84
    v_cvt_pk_bf16_f32 v90, v116, v117
    v_mul_f32 v118, v118, v84
    v_mul_f32 v119, v119, v84
    v_cvt_pk_bf16_f32 v91, v118, v119
    v_mul_f32 v120, v120, v84
    v_mul_f32 v121, v121, v84
    v_cvt_pk_bf16_f32 v92, v120, v121
    v_mul_f32 v122, v122, v84
    v_mul_f32 v123, v123, v84
    v_cvt_pk_bf16_f32 v93, v122, v123
    v_mul_f32 v124, v124, v84
    v_mul_f32 v125, v125, v84
    v_cvt_pk_bf16_f32 v94, v124, v125
    v_mul_f32 v126, v126, v84
    v_mul_f32 v127, v127, v84
    v_cvt_pk_bf16_f32 v95, v126, v127
    v_fma_f32 v112, v64, s27, v81
    v_fma_f32 v113, v65, s27, v81
    v_fma_f32 v114, v66, s27, v81
    v_fma_f32 v115, v67, s27, v81
    v_exp_f32 v112, v112
    v_exp_f32 v113, v113
    v_exp_f32 v114, v114
    s_bfe_u32 s32, s34, 262144
    s_lshl_b32 s32, s32, 13
    s_add_u32 s32, s32, s68
    buffer_load_dwordx4 a[0:3], v1, s[48:51], s32 offen offset:0 sc1
    v_exp_f32 v115, v115
    v_fma_f32 v116, v68, s27, v81
    v_fma_f32 v117, v69, s27, v81
    v_fma_f32 v118, v70, s27, v81
    v_fma_f32 v119, v71, s27, v81
    v_exp_f32 v116, v116
    v_exp_f32 v117, v117
    v_exp_f32 v118, v118
    v_exp_f32 v119, v119
    v_fma_f32 v120, v72, s27, v81
    v_fma_f32 v121, v73, s27, v81
    buffer_load_dwordx4 a[4:7], v1, s[48:51], s32 offen offset:1024 sc1
    v_fma_f32 v122, v74, s27, v81
    v_fma_f32 v123, v75, s27, v81
    v_exp_f32 v120, v120
    v_exp_f32 v121, v121
    buffer_load_dwordx4 a[8:11], v1, s[48:51], s32 offen offset:2048 sc1
    v_exp_f32 v122, v122
    v_exp_f32 v123, v123
    buffer_load_dwordx4 a[12:15], v1, s[48:51], s32 offen offset:3072 sc1
    v_fma_f32 v124, v76, s27, v83
    v_fma_f32 v125, v77, s27, v83
    v_fma_f32 v126, v78, s27, v83
    s_bfe_u32 s32, s34, 262148
    s_lshl_b32 s32, s32, 13
    s_add_u32 s32, s32, s68
    buffer_load_dwordx4 a[16:19], v1, s[48:51], s32 offen offset:0 sc1
    v_fma_f32 v127, v79, s27, v83
    v_exp_f32 v124, v124
    v_exp_f32 v125, v125
    v_exp_f32 v126, v126
    v_exp_f32 v127, v127
    v_add_f32 v84, v112, v113
    v_add_f32 v87, v114, v115
    v_add_f32 v84, v84, v116
    v_add_f32 v87, v87, v117
    v_add_f32 v84, v84, v118
    v_add_f32 v87, v87, v119
    v_add_f32 v84, v84, v120
    v_add_f32 v87, v87, v121
    v_add_f32 v84, v84, v122
    buffer_load_dwordx4 a[20:23], v1, s[48:51], s32 offen offset:1024 sc1
    v_add_f32 v87, v87, v123
    v_add_f32 v84, v84, v124
    v_add_f32 v87, v87, v125
    v_add_f32 v84, v84, v126
    buffer_load_dwordx4 a[24:27], v1, s[48:51], s32 offen offset:2048 sc1
    v_add_f32 v87, v87, v127
    v_add_f32 v84, v84, v87
    v_mov_b32 v87, v84
    s_nop 1
    v_permlane32_swap_b32 v84, v87
    v_add_f32 v84, v84, v87
    buffer_load_dwordx4 a[28:31], v1, s[48:51], s32 offen offset:3072 sc1
    v_rcp_f32 v84, v84
    s_nop 0
    v_mul_f32 v112, v112, v84
    v_mul_f32 v113, v113, v84
    s_bfe_u32 s32, s34, 262152
    s_lshl_b32 s32, s32, 13
    s_add_u32 s32, s32, s68
    buffer_load_dwordx4 a[32:35], v1, s[48:51], s32 offen offset:0 sc1
    v_cvt_pk_bf16_f32 v96, v112, v113
    v_mul_f32 v114, v114, v84
    v_mul_f32 v115, v115, v84
    v_cvt_pk_bf16_f32 v97, v114, v115
    v_mul_f32 v116, v116, v84
    v_mul_f32 v117, v117, v84
    v_cvt_pk_bf16_f32 v98, v116, v117
    v_mul_f32 v118, v118, v84
    v_mul_f32 v119, v119, v84
    v_cvt_pk_bf16_f32 v99, v118, v119
    v_mul_f32 v120, v120, v84
    v_mul_f32 v121, v121, v84
    v_cvt_pk_bf16_f32 v100, v120, v121
    v_mul_f32 v122, v122, v84
    v_mul_f32 v123, v123, v84
    v_cvt_pk_bf16_f32 v101, v122, v123
    v_mul_f32 v124, v124, v84
    buffer_load_dwordx4 a[36:39], v1, s[48:51], s32 offen offset:1024 sc1
    v_mul_f32 v125, v125, v84
    v_cvt_pk_bf16_f32 v102, v124, v125
    v_mul_f32 v126, v126, v84
    v_mul_f32 v127, v127, v84
    v_cvt_pk_bf16_f32 v103, v126, v127
    buffer_load_dwordx4 a[40:43], v1, s[48:51], s32 offen offset:2048 sc1
    ds_write_b64 v24, v[88:89] offset:0
    ds_write_b64 v24, v[90:91] offset:16
    ds_write_b64 v24, v[92:93] offset:32
    ds_write_b64 v24, v[94:95] offset:48
    buffer_load_dwordx4 a[44:47], v1, s[48:51], s32 offen offset:3072 sc1
    ds_write_b64 v24, v[96:97] offset:64
    ds_write_b64 v24, v[98:99] offset:80
    ds_write_b64 v24, v[100:101] offset:96
    ds_write_b64 v24, v[102:103] offset:112
    s_mov_b64 exec, 1
    buffer_store_dword v27, off, s[40:43], s64 sc1
    s_mov_b64 exec, -1
    s_waitcnt lgkmcnt(0)
    s_barrier
    v_add_u32 v136, 57344, v25
    v_add_u32 v137, 57344, v1
    ds_read_b64_tr_b16 v[64:65], v25 offset:0
    ds_read_b64_tr_b16 v[66:67], v25 offset:1088
    ds_read_b128 v[96:99], v1 offset:8192
    ds_read_b64_tr_b16 v[68:69], v25 offset:2176
    ds_read_b64_tr_b16 v[70:71], v25 offset:3264
    ds_read_b128 v[100:103], v1 offset:9216
    ds_read_b64_tr_b16 v[72:73], v25 offset:28672
    ds_read_b64_tr_b16 v[74:75], v25 offset:29760
    ds_read_b128 v[104:107], v1 offset:36864
    ds_read_b64_tr_b16 v[76:77], v25 offset:30848
    ds_read_b64_tr_b16 v[78:79], v25 offset:31936
    ds_read_b128 v[108:111], v1 offset:37888
    ds_read_b64_tr_b16 v[80:81], v136 offset:0
    ds_read_b64_tr_b16 v[82:83], v136 offset:1088
    ds_read_b128 v[112:115], v137 offset:8192
    ds_read_b64_tr_b16 v[84:85], v136 offset:2176
    ds_read_b64_tr_b16 v[86:87], v136 offset:3264
    ds_read_b128 v[116:119], v137 offset:9216
    ds_read_b64_tr_b16 v[88:89], v136 offset:28672
    ds_read_b64_tr_b16 v[90:91], v136 offset:29760
    ds_read_b128 v[120:123], v137 offset:36864
    ds_read_b64_tr_b16 v[92:93], v136 offset:30848
    ds_read_b64_tr_b16 v[94:95], v136 offset:31936
    ds_read_b128 v[124:127], v137 offset:37888
    s_waitcnt lgkmcnt(15)
    v_mfma_f32_32x32x16_bf16 v[32:47], v[64:67], v[96:99], 0
    v_mfma_f32_32x32x16_bf16 v[32:47], v[68:71], v[100:103], v[32:47]
    v_mfma_f32_32x32x16_bf16 v[32:47], v[72:75], v[104:107], v[32:47]
    s_waitcnt lgkmcnt(12)
    v_mfma_f32_32x32x16_bf16 v[32:47], v[76:79], v[108:111], v[32:47]
    s_waitcnt lgkmcnt(9)
    v_mfma_f32_32x32x16_bf16 v[32:47], v[80:83], v[112:115], v[32:47]
    s_waitcnt lgkmcnt(6)
    v_mfma_f32_32x32x16_bf16 v[32:47], v[84:87], v[116:119], v[32:47]
    s_waitcnt lgkmcnt(3)
    v_mfma_f32_32x32x16_bf16 v[32:47], v[88:91], v[120:123], v[32:47]
    s_waitcnt lgkmcnt(0)
    v_mfma_f32_32x32x16_bf16 v[32:47], v[92:95], v[124:127], v[32:47]
    s_and_b32 s87, s78, 1
    s_cmp_eq_u32 s87, 1
    s_cselect_b64 s[100:101], -1, 0
    s_nop 8
    v_cndmask_b32 v64, v32, v40, s[100:101]
    v_cndmask_b32 v65, v33, v41, s[100:101]
    v_cndmask_b32 v66, v34, v42, s[100:101]
    v_cndmask_b32 v67, v35, v43, s[100:101]
    v_cndmask_b32 v68, v36, v44, s[100:101]
    v_cndmask_b32 v69, v37, v45, s[100:101]
    v_cndmask_b32 v70, v38, v46, s[100:101]
    v_cndmask_b32 v71, v39, v47, s[100:101]
    v_cvt_pk_bf16_f32 v80, v64, v65
    v_cvt_pk_bf16_f32 v81, v66, v67
    v_cvt_pk_bf16_f32 v82, v68, v69
    v_cvt_pk_bf16_f32 v83, v70, v71
    v_mov_b32 v30, -2
    v_min_u32 v80, v80, v30
    v_min_u32 v81, v81, v30
    v_min_u32 v82, v82, v30
    v_min_u32 v83, v83, v30
    s_lshl_b32 s87, s72, 12
    s_add_u32 s87, s87, s86
    buffer_store_dwordx4 v[80:83], v1, s[40:43], s87 offen sc1
    s_waitcnt lgkmcnt(0)
    s_barrier
    s_lshr_b32 s87, s73, 3
    s_lshl1_add_u32 s87, s87, s79
    s_lshl_b32 s87, s87, 7
    s_add_u32 s87, s87, 55296
    v_and_b32 v30, 31, v0
    v_lshlrev_b32 v30, 2, v30
    v_add_u32 v30, s87, v30
    ds_read_b32 v138, v30
    s_add_u32 m0, s80, 14336
    s_bfe_u32 s92, s33, 262144
    s_mul_i32 s92, s92, s37
    s_add_u32 s92, s92, s36
    buffer_load_dwordx4 v6, s[52:55], s92 offen lds
    buffer_load_dwordx4 v140, s[52:55], s92 offen offset:1024 lds
    s_add_u32 m0, s80, 22528
    s_bfe_u32 s92, s33, 262144
    s_mul_i32 s92, s92, s37
    s_add_u32 s92, s92, s36
    s_add_u32 s92, s92, 28672
    buffer_load_dwordx4 v6, s[52:55], s92 offen lds
    buffer_load_dwordx4 v140, s[52:55], s92 offen offset:1024 lds
    s_add_u32 m0, s80, 2048
    s_bfe_u32 s92, s33, 262148
    s_mul_i32 s92, s92, s37
    s_add_u32 s92, s92, s36
    buffer_load_dwordx4 v6, s[52:55], s92 offen lds
    buffer_load_dwordx4 v140, s[52:55], s92 offen offset:1024 lds
    s_waitcnt lgkmcnt(0)
    s_barrier
    ds_read_b64_tr_b16 v[80:81], v22 offset:12288
    ds_read_b64_tr_b16 v[82:83], v22 offset:13312
    ds_read_b64_tr_b16 v[84:85], v23 offset:12288
    ds_read_b64_tr_b16 v[86:87], v23 offset:13312
    v_sub_f32 v138, 1.0, v138
    s_barrier
    ds_read_b64_tr_b16 v[88:89], v22 offset:16384
    ds_read_b64_tr_b16 v[90:91], v22 offset:17408
    ds_read_b64_tr_b16 v[92:93], v23 offset:16384
    ds_read_b64_tr_b16 v[94:95], v23 offset:17408
    s_waitcnt vmcnt(19) lgkmcnt(4)
    v_mfma_f32_32x32x16_bf16 v[32:47], v[80:83], a[0:3], 0
    v_mfma_f32_32x32x16_bf16 v[48:63], v[84:87], a[0:3], 0
    ds_read_b64_tr_b16 v[96:97], v22 offset:20480
    ds_read_b64_tr_b16 v[98:99], v22 offset:21504
    ds_read_b64_tr_b16 v[100:101], v23 offset:20480
    ds_read_b64_tr_b16 v[102:103], v23 offset:21504
    s_waitcnt vmcnt(18) lgkmcnt(4)
    v_mfma_f32_32x32x16_bf16 v[32:47], v[88:91], a[4:7], v[32:47]
    v_mfma_f32_32x32x16_bf16 v[48:63], v[92:95], a[4:7], v[48:63]
    s_add_u32 m0, s80, 8192
    s_bfe_u32 s92, s33, 262148
    s_mul_i32 s92, s92, s37
    s_add_u32 s92, s92, s36
    s_add_u32 s92, s92, 28672
    buffer_load_dwordx4 v6, s[52:55], s92 offen lds
    buffer_load_dwordx4 v140, s[52:55], s92 offen offset:1024 lds
    s_barrier
    ds_read_b64_tr_b16 v[80:81], v22 offset:24576
    ds_read_b64_tr_b16 v[82:83], v22 offset:25600
    ds_read_b64_tr_b16 v[84:85], v23 offset:24576
    ds_read_b64_tr_b16 v[86:87], v23 offset:25600
    s_waitcnt vmcnt(19) lgkmcnt(4)
    v_mfma_f32_32x32x16_bf16 v[32:47], v[96:99], a[8:11], v[32:47]
    v_mfma_f32_32x32x16_bf16 v[48:63], v[100:103], a[8:11], v[48:63]
    s_add_u32 s88, s65, 1703936
    buffer_load_dword v137, v26, s[40:43], s88 offen sc1
    ds_read_b64_tr_b16 v[88:89], v20 offset:0
    ds_read_b64_tr_b16 v[90:91], v20 offset:1024
    ds_read_b64_tr_b16 v[92:93], v21 offset:0
    ds_read_b64_tr_b16 v[94:95], v21 offset:1024
    s_waitcnt vmcnt(19) lgkmcnt(4)
    v_mfma_f32_32x32x16_bf16 v[32:47], v[80:83], a[12:15], v[32:47]
    v_mfma_f32_32x32x16_bf16 v[48:63], v[84:87], a[12:15], v[48:63]
    s_add_u32 m0, s80, 16384
    s_bfe_u32 s92, s33, 262152
    s_mul_i32 s92, s92, s37
    s_add_u32 s92, s92, s36
    buffer_load_dwordx4 v6, s[52:55], s92 offen lds
    buffer_load_dwordx4 v140, s[52:55], s92 offen offset:1024 lds
    s_barrier
    ds_read_b64_tr_b16 v[96:97], v20 offset:2048
    ds_read_b64_tr_b16 v[98:99], v20 offset:3072
    ds_read_b64_tr_b16 v[100:101], v21 offset:2048
    ds_read_b64_tr_b16 v[102:103], v21 offset:3072
    s_waitcnt vmcnt(20) lgkmcnt(4)
    v_mfma_f32_32x32x16_bf16 v[32:47], v[88:91], a[16:19], v[32:47]
    s_waitcnt vmcnt(2)
    v_cmp_ne_u32 vcc, v27, v137
    s_cbranch_vccz POLLD_9
    s_add_u32 s88, s65, 1703936
    s_mov_b32 s91, 0x40000
POLL_8:
    buffer_load_dword v137, v26, s[40:43], s88 offen sc1
    s_waitcnt vmcnt(0)
    v_cmp_ne_u32 vcc, v27, v137
    s_cbranch_vccz POLLD_9
    s_sub_u32 s91, s91, 1
    s_cmp_eq_u32 s91, 0
    s_cbranch_scc1 POLLD_9
    s_sleep 1
    s_branch POLL_8
POLLD_9:
    s_bfe_u32 s32, s33, 262144
    s_mul_i32 s32, s32, s67
    s_add_u32 s32, s32, s39
    buffer_load_dwordx4 a[48:51], v1, s[48:51], s32 offen offset:0 sc1
    buffer_load_dwordx4 a[52:55], v1, s[48:51], s32 offen offset:1024 sc1
    buffer_load_dwordx4 a[56:59], v1, s[48:51], s32 offen offset:2048 sc1
    buffer_load_dwordx4 a[60:63], v1, s[48:51], s32 offen offset:3072 sc1
    s_bfe_u32 s32, s33, 262148
    s_mul_i32 s32, s32, s67
    s_add_u32 s32, s32, s39
    buffer_load_dwordx4 a[64:67], v1, s[48:51], s32 offen offset:0 sc1
    v_mfma_f32_32x32x16_bf16 v[48:63], v[92:95], a[16:19], v[48:63]
    s_add_u32 s92, s86, 0
    buffer_load_dwordx4 v[104:107], v1, s[40:43], s92 offen sc1
    s_add_u32 s92, s86, 4096
    buffer_load_dwordx4 v[108:111], v1, s[40:43], s92 offen sc1
    s_add_u32 s92, s86, 8192
    buffer_load_dwordx4 v[112:115], v1, s[40:43], s92 offen sc1
    s_add_u32 s92, s86, 12288
    buffer_load_dwordx4 v[116:119], v1, s[40:43], s92 offen sc1
    s_add_u32 s92, s86, 16384
    buffer_load_dwordx4 v[120:123], v1, s[40:43], s92 offen sc1
    s_add_u32 s92, s86, 20480
    buffer_load_dwordx4 v[124:127], v1, s[40:43], s92 offen sc1
    s_add_u32 s92, s86, 24576
    buffer_load_dwordx4 v[128:131], v1, s[40:43], s92 offen sc1
    s_add_u32 s92, s86, 28672
    buffer_load_dwordx4 v[132:135], v1, s[40:43], s92 offen sc1
    s_add_u32 s92, s86, 32768
    buffer_load_dwordx4 v[64:67], v1, s[40:43], s92 offen sc1
    s_add_u32 s92, s86, 36864
    buffer_load_dwordx4 v[68:71], v1, s[40:43], s92 offen sc1
    s_add_u32 s92, s86, 40960
    buffer_load_dwordx4 v[72:75], v1, s[40:43], s92 offen sc1
    s_add_u32 s92, s86, 45056
    buffer_load_dwordx4 v[76:79], v1, s[40:43], s92 offen sc1
    ds_read_b64_tr_b16 v[80:81], v20 offset:4096
    ds_read_b64_tr_b16 v[82:83], v20 offset:5120
    ds_read_b64_tr_b16 v[84:85], v21 offset:4096
    ds_read_b64_tr_b16 v[86:87], v21 offset:5120
    s_waitcnt lgkmcnt(4)
    v_mfma_f32_32x32x16_bf16 v[32:47], v[96:99], a[20:23], v[32:47]
    v_mfma_f32_32x32x16_bf16 v[48:63], v[100:103], a[20:23], v[48:63]
    s_add_u32 m0, s80, 24576
    s_bfe_u32 s92, s33, 262152
    s_mul_i32 s92, s92, s37
    s_add_u32 s92, s92, s36
    s_add_u32 s92, s92, 28672
    buffer_load_dwordx4 v6, s[52:55], s92 offen lds
    buffer_load_dwordx4 v140, s[52:55], s92 offen offset:1024 lds
    buffer_load_dwordx4 a[68:71], v1, s[48:51], s32 offen offset:1024 sc1
    s_barrier
    ds_read_b64_tr_b16 v[88:89], v20 offset:6144
    ds_read_b64_tr_b16 v[90:91], v20 offset:7168
    ds_read_b64_tr_b16 v[92:93], v21 offset:6144
    ds_read_b64_tr_b16 v[94:95], v21 offset:7168
    s_waitcnt lgkmcnt(4)
    v_mfma_f32_32x32x16_bf16 v[32:47], v[80:83], a[24:27], v[32:47]
    v_mfma_f32_32x32x16_bf16 v[48:63], v[84:87], a[24:27], v[48:63]
    buffer_load_dwordx4 a[72:75], v1, s[48:51], s32 offen offset:2048 sc1
    ds_read_b64_tr_b16 v[96:97], v20 offset:8192
    ds_read_b64_tr_b16 v[98:99], v20 offset:9216
    ds_read_b64_tr_b16 v[100:101], v21 offset:8192
    ds_read_b64_tr_b16 v[102:103], v21 offset:9216
    s_waitcnt lgkmcnt(4)
    v_mfma_f32_32x32x16_bf16 v[32:47], v[88:91], a[28:31], v[32:47]
    s_add_u32 m0, s35, 2048
    s_bfe_u32 s92, s33, 262156
    s_mul_i32 s92, s92, s37
    s_add_u32 s92, s92, s36
    buffer_load_dwordx4 v6, s[52:55], s92 offen lds
    buffer_load_dwordx4 v140, s[52:55], s92 offen offset:1024 lds
    buffer_load_dwordx4 a[76:79], v1, s[48:51], s32 offen offset:3072 sc1
    s_waitcnt vmcnt(7)
    v_max3_u32 v136, v104, v105, v106
    v_max3_u32 v136, v136, v107, v108
    v_max3_u32 v136, v136, v109, v110
    v_max3_u32 v136, v136, v111, v112
    v_max3_u32 v136, v136, v113, v114
    v_max3_u32 v136, v136, v115, v116
    v_max3_u32 v136, v136, v117, v118
    v_max3_u32 v136, v136, v119, v120
    v_max3_u32 v136, v136, v121, v122
    v_max3_u32 v136, v136, v123, v124
    v_max3_u32 v136, v136, v125, v126
    v_max3_u32 v136, v136, v127, v128
    v_max3_u32 v136, v136, v129, v130
    v_max3_u32 v136, v136, v131, v132
    v_max3_u32 v136, v136, v133, v134
    v_max3_u32 v136, v136, v135, v64
    v_max3_u32 v136, v136, v65, v66
    v_max3_u32 v136, v136, v67, v68
    v_max3_u32 v136, v136, v69, v70
    v_max3_u32 v136, v136, v71, v72
    v_max3_u32 v136, v136, v73, v74
    v_max3_u32 v136, v136, v75, v76
    v_max3_u32 v136, v136, v77, v78
    v_max_u32 v136, v136, v79
    v_cmp_eq_u32 vcc, -1, v136
    s_cbranch_vccz GD_11
    s_mov_b32 s91, 0x40000
GC_10:
    s_sleep 2
    s_add_u32 s92, s86, 0
    buffer_load_dwordx4 v[104:107], v1, s[40:43], s92 offen sc1
    s_add_u32 s92, s86, 4096
    buffer_load_dwordx4 v[108:111], v1, s[40:43], s92 offen sc1
    s_add_u32 s92, s86, 8192
    buffer_load_dwordx4 v[112:115], v1, s[40:43], s92 offen sc1
    s_add_u32 s92, s86, 12288
    buffer_load_dwordx4 v[116:119], v1, s[40:43], s92 offen sc1
    s_add_u32 s92, s86, 16384
    buffer_load_dwordx4 v[120:123], v1, s[40:43], s92 offen sc1
    s_add_u32 s92, s86, 20480
    buffer_load_dwordx4 v[124:127], v1, s[40:43], s92 offen sc1
    s_add_u32 s92, s86, 24576
    buffer_load_dwordx4 v[128:131], v1, s[40:43], s92 offen sc1
    s_add_u32 s92, s86, 28672
    buffer_load_dwordx4 v[132:135], v1, s[40:43], s92 offen sc1
    s_add_u32 s92, s86, 32768
    buffer_load_dwordx4 v[64:67], v1, s[40:43], s92 offen sc1
    s_add_u32 s92, s86, 36864
    buffer_load_dwordx4 v[68:71], v1, s[40:43], s92 offen sc1
    s_add_u32 s92, s86, 40960
    buffer_load_dwordx4 v[72:75], v1, s[40:43], s92 offen sc1
    s_add_u32 s92, s86, 45056
    buffer_load_dwordx4 v[76:79], v1, s[40:43], s92 offen sc1
    s_waitcnt vmcnt(0)
    v_max3_u32 v136, v104, v105, v106
    v_max3_u32 v136, v136, v107, v108
    v_max3_u32 v136, v136, v109, v110
    v_max3_u32 v136, v136, v111, v112
    v_max3_u32 v136, v136, v113, v114
    v_max3_u32 v136, v136, v115, v116
    v_max3_u32 v136, v136, v117, v118
    v_max3_u32 v136, v136, v119, v120
    v_max3_u32 v136, v136, v121, v122
    v_max3_u32 v136, v136, v123, v124
    v_max3_u32 v136, v136, v125, v126
    v_max3_u32 v136, v136, v127, v128
    v_max3_u32 v136, v136, v129, v130
    v_max3_u32 v136, v136, v131, v132
    v_max3_u32 v136, v136, v133, v134
    v_max3_u32 v136, v136, v135, v64
    v_max3_u32 v136, v136, v65, v66
    v_max3_u32 v136, v136, v67, v68
    v_max3_u32 v136, v136, v69, v70
    v_max3_u32 v136, v136, v71, v72
    v_max3_u32 v136, v136, v73, v74
    v_max3_u32 v136, v136, v75, v76
    v_max3_u32 v136, v136, v77, v78
    v_max_u32 v136, v136, v79
    v_cmp_eq_u32 vcc, -1, v136
    s_cbranch_vccz GD_11
    s_sub_u32 s91, s91, 1
    s_cmp_eq_u32 s91, 0
    s_cbranch_scc1 GD_11
    s_branch GC_10
GD_11:
    v_mov_b32 v30, 0x00003f80
    v_mov_b32 v31, 0x3f800000
    v_dot2_f32_bf16 v7, v104, v30, 0
    v_dot2_f32_bf16 v8, v104, v31, 0
    v_dot2_f32_bf16 v9, v105, v30, 0
    v_dot2_f32_bf16 v10, v105, v31, 0
    v_dot2_f32_bf16 v11, v106, v30, 0
    v_dot2_f32_bf16 v12, v106, v31, 0
    v_mfma_f32_32x32x16_bf16 v[48:63], v[92:95], a[28:31], v[48:63]
    v_dot2_f32_bf16 v13, v107, v30, 0
    v_dot2_f32_bf16 v14, v107, v31, 0
    v_dot2_f32_bf16 v7, v108, v30, v7
    v_dot2_f32_bf16 v8, v108, v31, v8
    v_dot2_f32_bf16 v9, v109, v30, v9
    v_dot2_f32_bf16 v10, v109, v31, v10
    v_dot2_f32_bf16 v11, v110, v30, v11
    v_dot2_f32_bf16 v12, v110, v31, v12
    v_dot2_f32_bf16 v13, v111, v30, v13
    v_dot2_f32_bf16 v14, v111, v31, v14
    v_dot2_f32_bf16 v7, v112, v30, v7
    v_dot2_f32_bf16 v8, v112, v31, v8
    v_dot2_f32_bf16 v9, v113, v30, v9
    v_dot2_f32_bf16 v10, v113, v31, v10
    v_dot2_f32_bf16 v11, v114, v30, v11
    v_dot2_f32_bf16 v12, v114, v31, v12
    v_dot2_f32_bf16 v13, v115, v30, v13
    v_dot2_f32_bf16 v14, v115, v31, v14
    v_dot2_f32_bf16 v7, v116, v30, v7
    v_dot2_f32_bf16 v8, v116, v31, v8
    v_dot2_f32_bf16 v9, v117, v30, v9
    v_dot2_f32_bf16 v10, v117, v31, v10
    v_dot2_f32_bf16 v11, v118, v30, v11
    v_dot2_f32_bf16 v12, v118, v31, v12
    v_dot2_f32_bf16 v13, v119, v30, v13
    v_dot2_f32_bf16 v14, v119, v31, v14
    v_dot2_f32_bf16 v7, v120, v30, v7
    v_dot2_f32_bf16 v8, v120, v31, v8
    v_dot2_f32_bf16 v9, v121, v30, v9
    v_dot2_f32_bf16 v10, v121, v31, v10
    v_dot2_f32_bf16 v11, v122, v30, v11
    v_dot2_f32_bf16 v12, v122, v31, v12
    v_dot2_f32_bf16 v13, v123, v30, v13
    v_dot2_f32_bf16 v14, v123, v31, v14
    v_dot2_f32_bf16 v7, v124, v30, v7
    v_dot2_f32_bf16 v8, v124, v31, v8
    v_dot2_f32_bf16 v9, v125, v30, v9
    v_dot2_f32_bf16 v10, v125, v31, v10
    v_dot2_f32_bf16 v11, v126, v30, v11
    v_dot2_f32_bf16 v12, v126, v31, v12
    v_dot2_f32_bf16 v13, v127, v30, v13
    v_dot2_f32_bf16 v14, v127, v31, v14
    v_dot2_f32_bf16 v7, v128, v30, v7
    v_dot2_f32_bf16 v8, v128, v31, v8
    v_dot2_f32_bf16 v9, v129, v30, v9
    v_dot2_f32_bf16 v10, v129, v31, v10
    v_dot2_f32_bf16 v11, v130, v30, v11
    v_dot2_f32_bf16 v12, v130, v31, v12
    v_dot2_f32_bf16 v13, v131, v30, v13
    v_dot2_f32_bf16 v14, v131, v31, v14
    v_dot2_f32_bf16 v7, v132, v30, v7
    v_dot2_f32_bf16 v8, v132, v31, v8
    v_dot2_f32_bf16 v9, v133, v30, v9
    v_dot2_f32_bf16 v10, v133, v31, v10
    v_dot2_f32_bf16 v11, v134, v30, v11
    v_dot2_f32_bf16 v12, v134, v31, v12
    v_dot2_f32_bf16 v13, v135, v30, v13
    v_dot2_f32_bf16 v14, v135, v31, v14
    v_dot2_f32_bf16 v7, v64, v30, v7
    v_dot2_f32_bf16 v8, v64, v31, v8
    v_dot2_f32_bf16 v9, v65, v30, v9
    v_dot2_f32_bf16 v10, v65, v31, v10
    v_dot2_f32_bf16 v11, v66, v30, v11
    v_dot2_f32_bf16 v12, v66, v31, v12
    v_dot2_f32_bf16 v13, v67, v30, v13
    v_dot2_f32_bf16 v14, v67, v31, v14
    v_dot2_f32_bf16 v7, v68, v30, v7
    v_dot2_f32_bf16 v8, v68, v31, v8
    v_dot2_f32_bf16 v9, v69, v30, v9
    v_dot2_f32_bf16 v10, v69, v31, v10
    v_dot2_f32_bf16 v11, v70, v30, v11
    v_dot2_f32_bf16 v12, v70, v31, v12
    v_dot2_f32_bf16 v13, v71, v30, v13
    v_dot2_f32_bf16 v14, v71, v31, v14
    v_dot2_f32_bf16 v7, v72, v30, v7
    v_dot2_f32_bf16 v8, v72, v31, v8
    v_dot2_f32_bf16 v9, v73, v30, v9
    v_dot2_f32_bf16 v10, v73, v31, v10
    v_dot2_f32_bf16 v11, v74, v30, v11
    v_dot2_f32_bf16 v12, v74, v31, v12
    v_dot2_f32_bf16 v13, v75, v30, v13
    v_dot2_f32_bf16 v14, v75, v31, v14
    v_dot2_f32_bf16 v7, v76, v30, v7
    v_dot2_f32_bf16 v8, v76, v31, v8
    v_dot2_f32_bf16 v9, v77, v30, v9
    v_dot2_f32_bf16 v10, v77, v31, v10
    v_dot2_f32_bf16 v11, v78, v30, v11
    v_dot2_f32_bf16 v12, v78, v31, v12
    v_dot2_f32_bf16 v13, v79, v30, v13
    v_dot2_f32_bf16 v14, v79, v31, v14
    s_add_u32 s92, s86, 49152
    buffer_load_dwordx4 v[64:67], v1, s[40:43], s92 offen sc1
    s_add_u32 s92, s86, 53248
    buffer_load_dwordx4 v[68:71], v1, s[40:43], s92 offen sc1
    s_add_u32 s92, s86, 57344
    buffer_load_dwordx4 v[72:75], v1, s[40:43], s92 offen sc1
    s_add_u32 s92, s86, 61440
    buffer_load_dwordx4 v[76:79], v1, s[40:43], s92 offen sc1
    s_barrier
    ds_read_b64_tr_b16 v[80:81], v20 offset:10240
    ds_read_b64_tr_b16 v[82:83], v20 offset:11264
    ds_read_b64_tr_b16 v[84:85], v21 offset:10240
    ds_read_b64_tr_b16 v[86:87], v21 offset:11264
    s_waitcnt lgkmcnt(4)
    v_mfma_f32_32x32x16_bf16 v[32:47], v[96:99], a[32:35], v[32:47]
    v_mfma_f32_32x32x16_bf16 v[48:63], v[100:103], a[32:35], v[48:63]
    s_bfe_u32 s32, s33, 262152
    s_mul_i32 s32, s32, s67
    s_add_u32 s32, s32, s39
    buffer_load_dwordx4 a[80:83], v1, s[48:51], s32 offen offset:0 sc1
    ds_read_b64_tr_b16 v[88:89], v22 offset:6144
    ds_read_b64_tr_b16 v[90:91], v22 offset:7168
    ds_read_b64_tr_b16 v[92:93], v23 offset:6144
    ds_read_b64_tr_b16 v[94:95], v23 offset:7168
    s_waitcnt lgkmcnt(4)
    v_mfma_f32_32x32x16_bf16 v[32:47], v[80:83], a[36:39], v[32:47]
    s_add_u32 m0, s35, 6144
    s_bfe_u32 s92, s33, 262156
    s_mul_i32 s92, s92, s37
    s_add_u32 s92, s92, s36
    s_add_u32 s92, s92, 28672
    buffer_load_dwordx4 v6, s[52:55], s92 offen lds
    buffer_load_dwordx4 v140, s[52:55], s92 offen offset:1024 lds
    buffer_load_dwordx4 a[84:87], v1, s[48:51], s32 offen offset:1024 sc1
    v_mfma_f32_32x32x16_bf16 v[48:63], v[84:87], a[36:39], v[48:63]
    s_waitcnt vmcnt(4)
    v_max3_u32 v136, v64, v65, v66
    v_max3_u32 v136, v136, v67, v68
    v_max3_u32 v136, v136, v69, v70
    v_max3_u32 v136, v136, v71, v72
    v_max3_u32 v136, v136, v73, v74
    v_max3_u32 v136, v136, v75, v76
    v_max3_u32 v136, v136, v77, v78
    v_max_u32 v136, v136, v79
    v_cmp_eq_u32 vcc, -1, v136
    s_cbranch_vccz GD_13
    s_mov_b32 s91, 0x40000
GC_12:
    s_sleep 2
    s_add_u32 s92, s86, 49152
    buffer_load_dwordx4 v[64:67], v1, s[40:43], s92 offen sc1
    s_add_u32 s92, s86, 53248
    buffer_load_dwordx4 v[68:71], v1, s[40:43], s92 offen sc1
    s_add_u32 s92, s86, 57344
    buffer_load_dwordx4 v[72:75], v1, s[40:43], s92 offen sc1
    s_add_u32 s92, s86, 61440
    buffer_load_dwordx4 v[76:79], v1, s[40:43], s92 offen sc1
    s_waitcnt vmcnt(0)
    v_max3_u32 v136, v64, v65, v66
    v_max3_u32 v136, v136, v67, v68
    v_max3_u32 v136, v136, v69, v70
    v_max3_u32 v136, v136, v71, v72
    v_max3_u32 v136, v136, v73, v74
    v_max3_u32 v136, v136, v75, v76
    v_max3_u32 v136, v136, v77, v78
    v_max_u32 v136, v136, v79
    v_cmp_eq_u32 vcc, -1, v136
    s_cbranch_vccz GD_13
    s_sub_u32 s91, s91, 1
    s_cmp_eq_u32 s91, 0
    s_cbranch_scc1 GD_13
    s_branch GC_12
GD_13:
    v_dot2_f32_bf16 v7, v64, v30, v7
    v_dot2_f32_bf16 v8, v64, v31, v8
    v_dot2_f32_bf16 v9, v65, v30, v9
    v_dot2_f32_bf16 v10, v65, v31, v10
    v_dot2_f32_bf16 v11, v66, v30, v11
    v_dot2_f32_bf16 v12, v66, v31, v12
    v_dot2_f32_bf16 v13, v67, v30, v13
    v_dot2_f32_bf16 v14, v67, v31, v14
    v_dot2_f32_bf16 v7, v68, v30, v7
    v_dot2_f32_bf16 v8, v68, v31, v8
    v_dot2_f32_bf16 v9, v69, v30, v9
    v_dot2_f32_bf16 v10, v69, v31, v10
    v_dot2_f32_bf16 v11, v70, v30, v11
    v_dot2_f32_bf16 v12, v70, v31, v12
    v_dot2_f32_bf16 v13, v71, v30, v13
    v_dot2_f32_bf16 v14, v71, v31, v14
    v_dot2_f32_bf16 v7, v72, v30, v7
    v_dot2_f32_bf16 v8, v72, v31, v8
    v_dot2_f32_bf16 v9, v73, v30, v9
    v_dot2_f32_bf16 v10, v73, v31, v10
    v_dot2_f32_bf16 v11, v74, v30, v11
    v_dot2_f32_bf16 v12, v74, v31, v12
    v_dot2_f32_bf16 v13, v75, v30, v13
    v_dot2_f32_bf16 v14, v75, v31, v14
    v_dot2_f32_bf16 v7, v76, v30, v7
    v_dot2_f32_bf16 v8, v76, v31, v8
    v_dot2_f32_bf16 v9, v77, v30, v9
    v_dot2_f32_bf16 v10, v77, v31, v10
    v_dot2_f32_bf16 v11, v78, v30, v11
    v_dot2_f32_bf16 v12, v78, v31, v12
    v_dot2_f32_bf16 v13, v79, v30, v13
    v_dot2_f32_bf16 v14, v79, v31, v14
    v_cvt_pk_bf16_f32 v64, v7, v8
    v_cvt_pk_bf16_f32 v65, v9, v10
    v_cvt_pk_bf16_f32 v66, v11, v12
    v_cvt_pk_bf16_f32 v67, v13, v14
    v_add_u32 v136, s80, v1
    ds_write_b128 v136, v[64:67] offset:27648
    s_waitcnt lgkmcnt(0)
    s_barrier
    ds_read_b64_tr_b16 v[96:97], v22 offset:10240
    ds_read_b64_tr_b16 v[98:99], v22 offset:11264
    ds_read_b64_tr_b16 v[100:101], v23 offset:10240
    ds_read_b64_tr_b16 v[102:103], v23 offset:11264
    v_mfma_f32_32x32x16_bf16 v[32:47], v[88:91], a[40:43], v[32:47]
    v_mfma_f32_32x32x16_bf16 v[48:63], v[92:95], a[40:43], v[48:63]
    buffer_load_dwordx4 a[88:91], v1, s[48:51], s32 offen offset:2048 sc1
    ds_read_b64_tr_b16 v[80:81], v22 offset:14336
    ds_read_b64_tr_b16 v[82:83], v22 offset:15360
    ds_read_b64_tr_b16 v[84:85], v23 offset:14336
    ds_read_b64_tr_b16 v[86:87], v23 offset:15360
    s_waitcnt lgkmcnt(4)
    v_mfma_f32_32x32x16_bf16 v[32:47], v[96:99], a[44:47], v[32:47]
    v_mfma_f32_32x32x16_bf16 v[48:63], v[100:103], a[44:47], v[48:63]
    s_add_u32 m0, s35, 10240
    s_bfe_u32 s92, s33, 262144
    s_mul_i32 s92, s92, 25088
    s_add_u32 s92, s92, s30
    buffer_load_dwordx4 v6, s[56:59], s92 offen lds
    buffer_load_dwordx4 v140, s[56:59], s92 offen offset:1024 lds
    buffer_load_dwordx4 a[92:95], v1, s[48:51], s32 offen offset:3072 sc1
    s_barrier
    ds_read_b64_tr_b16 v[88:89], v22 offset:18432
    ds_read_b64_tr_b16 v[90:91], v22 offset:19456
    ds_read_b64_tr_b16 v[92:93], v23 offset:18432
    ds_read_b64_tr_b16 v[94:95], v23 offset:19456
    s_waitcnt lgkmcnt(4)
    v_mfma_f32_32x32x16_bf16 v[32:47], v[80:83], a[48:51], v[32:47]
    v_mfma_f32_32x32x16_bf16 v[48:63], v[84:87], a[48:51], v[48:63]
    s_bfe_u32 s32, s33, 262156
    s_mul_i32 s32, s32, s67
    s_add_u32 s32, s32, s39
    buffer_load_dwordx4 a[96:99], v1, s[48:51], s32 offen offset:0 sc1
    ds_read_b64_tr_b16 v[96:97], v22 offset:22528
    ds_read_b64_tr_b16 v[98:99], v22 offset:23552
    ds_read_b64_tr_b16 v[100:101], v23 offset:22528
    ds_read_b64_tr_b16 v[102:103], v23 offset:23552
    s_waitcnt lgkmcnt(4)
    v_mfma_f32_32x32x16_bf16 v[32:47], v[88:91], a[52:55], v[32:47]
    v_mfma_f32_32x32x16_bf16 v[48:63], v[92:95], a[52:55], v[48:63]
    s_add_u32 m0, s80, 10240
    s_bfe_u32 s92, s33, 262148
    s_mul_i32 s92, s92, 25088
    s_add_u32 s92, s92, s30
    buffer_load_dwordx4 v6, s[56:59], s92 offen lds
    buffer_load_dwordx4 v140, s[56:59], s92 offen offset:1024 lds
    buffer_load_dwordx4 a[100:103], v1, s[48:51], s32 offen offset:1024 sc1
    s_barrier
    ds_read_b64_tr_b16 v[80:81], v22 offset:0
    ds_read_b64_tr_b16 v[82:83], v22 offset:1024
    ds_read_b64_tr_b16 v[84:85], v23 offset:0
    ds_read_b64_tr_b16 v[86:87], v23 offset:1024
    s_waitcnt lgkmcnt(4)
    v_mfma_f32_32x32x16_bf16 v[32:47], v[96:99], a[56:59], v[32:47]
    v_mfma_f32_32x32x16_bf16 v[48:63], v[100:103], a[56:59], v[48:63]
    buffer_load_dwordx4 a[104:107], v1, s[48:51], s32 offen offset:2048 sc1
    ds_read_b64_tr_b16 v[88:89], v22 offset:2048
    ds_read_b64_tr_b16 v[90:91], v22 offset:3072
    ds_read_b64_tr_b16 v[92:93], v23 offset:2048
    ds_read_b64_tr_b16 v[94:95], v23 offset:3072
    s_waitcnt lgkmcnt(4)
    v_mfma_f32_32x32x16_bf16 v[32:47], v[80:83], a[60:63], v[32:47]
    v_mfma_f32_32x32x16_bf16 v[48:63], v[84:87], a[60:63], v[48:63]
    s_add_u32 m0, s80, 18432
    s_bfe_u32 s92, s33, 262152
    s_mul_i32 s92, s92, 25088
    s_add_u32 s92, s92, s30
    buffer_load_dwordx4 v6, s[56:59], s92 offen lds
    buffer_load_dwordx4 v140, s[56:59], s92 offen offset:1024 lds
    buffer_load_dwordx4 a[108:111], v1, s[48:51], s32 offen offset:3072 sc1
    s_barrier
    ds_read_b64_tr_b16 v[96:97], v22 offset:4096
    ds_read_b64_tr_b16 v[98:99], v22 offset:5120
    ds_read_b64_tr_b16 v[100:101], v23 offset:4096
    ds_read_b64_tr_b16 v[102:103], v23 offset:5120
    s_waitcnt lgkmcnt(4)
    v_mfma_f32_32x32x16_bf16 v[32:47], v[88:91], a[64:67], v[32:47]
    v_mfma_f32_32x32x16_bf16 v[48:63], v[92:95], a[64:67], v[48:63]
    ds_read_b64_tr_b16 v[80:81], v22 offset:8192
    ds_read_b64_tr_b16 v[82:83], v22 offset:9216
    ds_read_b64_tr_b16 v[84:85], v23 offset:8192
    ds_read_b64_tr_b16 v[86:87], v23 offset:9216
    s_waitcnt lgkmcnt(4)
    v_mfma_f32_32x32x16_bf16 v[32:47], v[96:99], a[68:71], v[32:47]
    v_mfma_f32_32x32x16_bf16 v[48:63], v[100:103], a[68:71], v[48:63]
    s_add_u32 m0, s80, 0
    s_bfe_u32 s92, s33, 262156
    s_mul_i32 s92, s92, 25088
    s_add_u32 s92, s92, s30
    buffer_load_dwordx4 v6, s[56:59], s92 offen lds
    buffer_load_dwordx4 v140, s[56:59], s92 offen offset:1024 lds
    s_barrier
    ds_read_b64_tr_b16 v[88:89], v22 offset:12288
    ds_read_b64_tr_b16 v[90:91], v22 offset:13312
    ds_read_b64_tr_b16 v[92:93], v23 offset:12288
    ds_read_b64_tr_b16 v[94:95], v23 offset:13312
    s_waitcnt lgkmcnt(4)
    v_mfma_f32_32x32x16_bf16 v[32:47], v[80:83], a[72:75], v[32:47]
    v_mfma_f32_32x32x16_bf16 v[48:63], v[84:87], a[72:75], v[48:63]
    ds_read_b64_tr_b16 v[96:97], v22 offset:16384
    ds_read_b64_tr_b16 v[98:99], v22 offset:17408
    ds_read_b64_tr_b16 v[100:101], v23 offset:16384
    ds_read_b64_tr_b16 v[102:103], v23 offset:17408
    s_waitcnt lgkmcnt(4)
    v_mfma_f32_32x32x16_bf16 v[32:47], v[88:91], a[76:79], v[32:47]
    v_mfma_f32_32x32x16_bf16 v[48:63], v[92:95], a[76:79], v[48:63]
    s_barrier
    ds_read_b64_tr_b16 v[80:81], v22 offset:20480
    ds_read_b64_tr_b16 v[82:83], v22 offset:21504
    ds_read_b64_tr_b16 v[84:85], v23 offset:20480
    ds_read_b64_tr_b16 v[86:87], v23 offset:21504
    s_waitcnt vmcnt(17) lgkmcnt(4)
    v_mfma_f32_32x32x16_bf16 v[32:47], v[96:99], a[80:83], v[32:47]
    v_mfma_f32_32x32x16_bf16 v[48:63], v[100:103], a[80:83], v[48:63]
    ds_read_b64_tr_b16 v[88:89], v22 offset:24576
    ds_read_b64_tr_b16 v[90:91], v22 offset:25600
    ds_read_b64_tr_b16 v[92:93], v23 offset:24576
    ds_read_b64_tr_b16 v[94:95], v23 offset:25600
    s_waitcnt vmcnt(14) lgkmcnt(4)
    v_mfma_f32_32x32x16_bf16 v[32:47], v[80:83], a[84:87], v[32:47]
    v_mfma_f32_32x32x16_bf16 v[48:63], v[84:87], a[84:87], v[48:63]
    s_barrier
    ds_read_b64_tr_b16 v[96:97], v20 offset:0
    ds_read_b64_tr_b16 v[98:99], v20 offset:1024
    ds_read_b64_tr_b16 v[100:101], v21 offset:0
    ds_read_b64_tr_b16 v[102:103], v21 offset:1024
    s_waitcnt vmcnt(13) lgkmcnt(4)
    v_mfma_f32_32x32x16_bf16 v[32:47], v[88:91], a[88:91], v[32:47]
    s_bfe_u32 s92, s33, 262144
    s_lshl_b32 s92, s92, 11
    s_add_u32 s92, s92, s29
    buffer_load_dwordx4 v[104:107], v1, s[48:51], s92 offen sc1
    s_bfe_u32 s92, s33, 262144
    s_lshl_b32 s92, s92, 11
    s_add_u32 s92, s92, s29
    buffer_load_dwordx4 v[108:111], v1, s[48:51], s92 offen offset:1024 sc1
    s_bfe_u32 s92, s33, 262148
    s_lshl_b32 s92, s92, 11
    s_add_u32 s92, s92, s29
    buffer_load_dwordx4 v[112:115], v1, s[48:51], s92 offen sc1
    s_bfe_u32 s92, s33, 262148
    s_lshl_b32 s92, s92, 11
    s_add_u32 s92, s92, s29
    buffer_load_dwordx4 v[116:119], v1, s[48:51], s92 offen offset:1024 sc1
    v_mfma_f32_32x32x16_bf16 v[48:63], v[92:95], a[88:91], v[48:63]
    s_bfe_u32 s92, s33, 262152
    s_lshl_b32 s92, s92, 11
    s_add_u32 s92, s92, s29
    buffer_load_dwordx4 v[120:123], v1, s[48:51], s92 offen sc1
    s_bfe_u32 s92, s33, 262152
    s_lshl_b32 s92, s92, 11
    s_add_u32 s92, s92, s29
    buffer_load_dwordx4 v[124:127], v1, s[48:51], s92 offen offset:1024 sc1
    s_bfe_u32 s92, s33, 262156
    s_lshl_b32 s92, s92, 11
    s_add_u32 s92, s92, s29
    buffer_load_dwordx4 v[128:131], v1, s[48:51], s92 offen sc1
    s_bfe_u32 s92, s33, 262156
    s_lshl_b32 s92, s92, 11
    s_add_u32 s92, s92, s29
    buffer_load_dwordx4 v[132:135], v1, s[48:51], s92 offen offset:1024 sc1
    ds_read_b64_tr_b16 v[80:81], v20 offset:2048
    ds_read_b64_tr_b16 v[82:83], v20 offset:3072
    ds_read_b64_tr_b16 v[84:85], v21 offset:2048
    ds_read_b64_tr_b16 v[86:87], v21 offset:3072
    s_waitcnt vmcnt(18) lgkmcnt(4)
    v_mfma_f32_32x32x16_bf16 v[32:47], v[96:99], a[92:95], v[32:47]
    v_mfma_f32_32x32x16_bf16 v[48:63], v[100:103], a[92:95], v[48:63]
    s_barrier
    ds_read_b64_tr_b16 v[88:89], v20 offset:4096
    ds_read_b64_tr_b16 v[90:91], v20 offset:5120
    ds_read_b64_tr_b16 v[92:93], v21 offset:4096
    ds_read_b64_tr_b16 v[94:95], v21 offset:5120
    s_waitcnt vmcnt(17) lgkmcnt(4)
    v_mfma_f32_32x32x16_bf16 v[32:47], v[80:83], a[96:99], v[32:47]
    v_mfma_f32_32x32x16_bf16 v[48:63], v[84:87], a[96:99], v[48:63]
    ds_read_b64_tr_b16 v[96:97], v20 offset:6144
    ds_read_b64_tr_b16 v[98:99], v20 offset:7168
    ds_read_b64_tr_b16 v[100:101], v21 offset:6144
    ds_read_b64_tr_b16 v[102:103], v21 offset:7168
    s_waitcnt vmcnt(14) lgkmcnt(4)
    v_mfma_f32_32x32x16_bf16 v[32:47], v[88:91], a[100:103], v[32:47]
    v_mfma_f32_32x32x16_bf16 v[48:63], v[92:95], a[100:103], v[48:63]
    s_barrier
    ds_read_b64_tr_b16 v[80:81], v20 offset:8192
    ds_read_b64_tr_b16 v[82:83], v20 offset:9216
    ds_read_b64_tr_b16 v[84:85], v21 offset:8192
    ds_read_b64_tr_b16 v[86:87], v21 offset:9216
    s_waitcnt vmcnt(13) lgkmcnt(4)
    v_mfma_f32_32x32x16_bf16 v[32:47], v[96:99], a[104:107], v[32:47]
    v_mfma_f32_32x32x16_bf16 v[48:63], v[100:103], a[104:107], v[48:63]
    s_waitcnt vmcnt(0)
    v_max3_u32 v136, v104, v105, v106
    v_max3_u32 v136, v136, v107, v108
    v_max3_u32 v136, v136, v109, v110
    v_max3_u32 v136, v136, v111, v112
    v_max3_u32 v136, v136, v113, v114
    v_max3_u32 v136, v136, v115, v116
    v_max3_u32 v136, v136, v117, v118
    v_max3_u32 v136, v136, v119, v120
    v_max3_u32 v136, v136, v121, v122
    v_max3_u32 v136, v136, v123, v124
    v_max3_u32 v136, v136, v125, v126
    v_max3_u32 v136, v136, v127, v128
    v_max3_u32 v136, v136, v129, v130
    v_max3_u32 v136, v136, v131, v132
    v_max3_u32 v136, v136, v133, v134
    v_max_u32 v136, v136, v135
    v_cmp_eq_u32 vcc, -1, v136
    s_cbranch_vccz GD_15
    s_mov_b32 s91, 0x40000
GC_14:
    s_sleep 2
    s_bfe_u32 s92, s33, 262144
    s_lshl_b32 s92, s92, 11
    s_add_u32 s92, s92, s29
    buffer_load_dwordx4 v[104:107], v1, s[48:51], s92 offen sc1
    s_bfe_u32 s92, s33, 262144
    s_lshl_b32 s92, s92, 11
    s_add_u32 s92, s92, s29
    buffer_load_dwordx4 v[108:111], v1, s[48:51], s92 offen offset:1024 sc1
    s_bfe_u32 s92, s33, 262148
    s_lshl_b32 s92, s92, 11
    s_add_u32 s92, s92, s29
    buffer_load_dwordx4 v[112:115], v1, s[48:51], s92 offen sc1
    s_bfe_u32 s92, s33, 262148
    s_lshl_b32 s92, s92, 11
    s_add_u32 s92, s92, s29
    buffer_load_dwordx4 v[116:119], v1, s[48:51], s92 offen offset:1024 sc1
    s_bfe_u32 s92, s33, 262152
    s_lshl_b32 s92, s92, 11
    s_add_u32 s92, s92, s29
    buffer_load_dwordx4 v[120:123], v1, s[48:51], s92 offen sc1
    s_bfe_u32 s92, s33, 262152
    s_lshl_b32 s92, s92, 11
    s_add_u32 s92, s92, s29
    buffer_load_dwordx4 v[124:127], v1, s[48:51], s92 offen offset:1024 sc1
    s_bfe_u32 s92, s33, 262156
    s_lshl_b32 s92, s92, 11
    s_add_u32 s92, s92, s29
    buffer_load_dwordx4 v[128:131], v1, s[48:51], s92 offen sc1
    s_bfe_u32 s92, s33, 262156
    s_lshl_b32 s92, s92, 11
    s_add_u32 s92, s92, s29
    buffer_load_dwordx4 v[132:135], v1, s[48:51], s92 offen offset:1024 sc1
    s_waitcnt vmcnt(0)
    v_max3_u32 v136, v104, v105, v106
    v_max3_u32 v136, v136, v107, v108
    v_max3_u32 v136, v136, v109, v110
    v_max3_u32 v136, v136, v111, v112
    v_max3_u32 v136, v136, v113, v114
    v_max3_u32 v136, v136, v115, v116
    v_max3_u32 v136, v136, v117, v118
    v_max3_u32 v136, v136, v119, v120
    v_max3_u32 v136, v136, v121, v122
    v_max3_u32 v136, v136, v123, v124
    v_max3_u32 v136, v136, v125, v126
    v_max3_u32 v136, v136, v127, v128
    v_max3_u32 v136, v136, v129, v130
    v_max3_u32 v136, v136, v131, v132
    v_max3_u32 v136, v136, v133, v134
    v_max_u32 v136, v136, v135
    v_cmp_eq_u32 vcc, -1, v136
    s_cbranch_vccz GD_15
    s_sub_u32 s91, s91, 1
    s_cmp_eq_u32 s91, 0
    s_cbranch_scc1 GD_15
    s_branch GC_14
GD_15:
    ds_read_b64_tr_b16 v[88:89], v20 offset:10240
    ds_read_b64_tr_b16 v[90:91], v20 offset:11264
    ds_read_b64_tr_b16 v[92:93], v21 offset:10240
    ds_read_b64_tr_b16 v[94:95], v21 offset:11264
    s_waitcnt lgkmcnt(4)
    v_mfma_f32_32x32x16_bf16 v[32:47], v[80:83], a[108:111], v[32:47]
    v_mfma_f32_32x32x16_bf16 v[48:63], v[84:87], a[108:111], v[48:63]
    s_nop 10
    v_mul_f32 v32, v32, v138
    v_mul_f32 v33, v33, v138
    v_mul_f32 v34, v34, v138
    v_mul_f32 v35, v35, v138
    v_mul_f32 v36, v36, v138
    v_mul_f32 v37, v37, v138
    v_mul_f32 v38, v38, v138
    v_mul_f32 v39, v39, v138
    v_mul_f32 v40, v40, v138
    v_mul_f32 v41, v41, v138
    v_mul_f32 v42, v42, v138
    v_mul_f32 v43, v43, v138
    v_mul_f32 v44, v44, v138
    v_mul_f32 v45, v45, v138
    v_mul_f32 v46, v46, v138
    v_mul_f32 v47, v47, v138
    v_mul_f32 v48, v48, v138
    v_mul_f32 v49, v49, v138
    v_mul_f32 v50, v50, v138
    v_mul_f32 v51, v51, v138
    v_mul_f32 v52, v52, v138
    v_mul_f32 v53, v53, v138
    v_mul_f32 v54, v54, v138
    v_mul_f32 v55, v55, v138
    v_mul_f32 v56, v56, v138
    v_mul_f32 v57, v57, v138
    v_mul_f32 v58, v58, v138
    v_mul_f32 v59, v59, v138
    v_mul_f32 v60, v60, v138
    v_mul_f32 v61, v61, v138
    v_mul_f32 v62, v62, v138
    v_mul_f32 v63, v63, v138
    s_barrier
    ds_read_b64_tr_b16 v[96:97], v22 offset:6144
    ds_read_b64_tr_b16 v[98:99], v22 offset:7168
    ds_read_b64_tr_b16 v[100:101], v23 offset:6144
    ds_read_b64_tr_b16 v[102:103], v23 offset:7168
    s_waitcnt lgkmcnt(4)
    v_mfma_f32_32x32x16_bf16 v[32:47], v[88:91], v[104:107], v[32:47]
    v_mfma_f32_32x32x16_bf16 v[48:63], v[92:95], v[104:107], v[48:63]
    ds_read_b64_tr_b16 v[80:81], v22 offset:10240
    ds_read_b64_tr_b16 v[82:83], v22 offset:11264
    ds_read_b64_tr_b16 v[84:85], v23 offset:10240
    ds_read_b64_tr_b16 v[86:87], v23 offset:11264
    s_waitcnt lgkmcnt(4)
    v_mfma_f32_32x32x16_bf16 v[32:47], v[96:99], v[108:111], v[32:47]
    v_mfma_f32_32x32x16_bf16 v[48:63], v[100:103], v[108:111], v[48:63]
    s_barrier
    ds_read_b64_tr_b16 v[88:89], v22 offset:14336
    ds_read_b64_tr_b16 v[90:91], v22 offset:15360
    ds_read_b64_tr_b16 v[92:93], v23 offset:14336
    ds_read_b64_tr_b16 v[94:95], v23 offset:15360
    s_waitcnt lgkmcnt(4)
    v_mfma_f32_32x32x16_bf16 v[32:47], v[80:83], v[112:115], v[32:47]
    v_mfma_f32_32x32x16_bf16 v[48:63], v[84:87], v[112:115], v[48:63]
    ds_read_b64_tr_b16 v[96:97], v22 offset:18432
    ds_read_b64_tr_b16 v[98:99], v22 offset:19456
    ds_read_b64_tr_b16 v[100:101], v23 offset:18432
    ds_read_b64_tr_b16 v[102:103], v23 offset:19456
    s_waitcnt lgkmcnt(4)
    v_mfma_f32_32x32x16_bf16 v[32:47], v[88:91], v[116:119], v[32:47]
    v_mfma_f32_32x32x16_bf16 v[48:63], v[92:95], v[116:119], v[48:63]
    s_barrier
    ds_read_b64_tr_b16 v[80:81], v22 offset:22528
    ds_read_b64_tr_b16 v[82:83], v22 offset:23552
    ds_read_b64_tr_b16 v[84:85], v23 offset:22528
    ds_read_b64_tr_b16 v[86:87], v23 offset:23552
    s_waitcnt lgkmcnt(4)
    v_mfma_f32_32x32x16_bf16 v[32:47], v[96:99], v[120:123], v[32:47]
    v_mfma_f32_32x32x16_bf16 v[48:63], v[100:103], v[120:123], v[48:63]
    ds_read_b64_tr_b16 v[88:89], v22 offset:0
    ds_read_b64_tr_b16 v[90:91], v22 offset:1024
    ds_read_b64_tr_b16 v[92:93], v23 offset:0
    ds_read_b64_tr_b16 v[94:95], v23 offset:1024
    s_waitcnt lgkmcnt(4)
    v_mfma_f32_32x32x16_bf16 v[32:47], v[80:83], v[124:127], v[32:47]
    v_mfma_f32_32x32x16_bf16 v[48:63], v[84:87], v[124:127], v[48:63]
    ds_read_b64_tr_b16 v[96:97], v22 offset:2048
    ds_read_b64_tr_b16 v[98:99], v22 offset:3072
    ds_read_b64_tr_b16 v[100:101], v23 offset:2048
    ds_read_b64_tr_b16 v[102:103], v23 offset:3072
    s_waitcnt lgkmcnt(4)
    v_mfma_f32_32x32x16_bf16 v[32:47], v[88:91], v[128:131], v[32:47]
    v_mfma_f32_32x32x16_bf16 v[48:63], v[92:95], v[128:131], v[48:63]
    s_waitcnt lgkmcnt(0)
    v_mfma_f32_32x32x16_bf16 v[32:47], v[96:99], v[132:135], v[32:47]
    v_mfma_f32_32x32x16_bf16 v[48:63], v[100:103], v[132:135], v[48:63]
    s_barrier
    s_lshl_b32 s87, s74, 13
    v_add_u32 v30, s87, v1
    s_nop 7
    ds_write_b128 v30, v[32:35] offset:0
    ds_write_b128 v30, v[36:39] offset:1024
    ds_write_b128 v30, v[40:43] offset:2048
    ds_write_b128 v30, v[44:47] offset:3072
    ds_write_b128 v30, v[48:51] offset:4096
    ds_write_b128 v30, v[52:55] offset:5120
    ds_write_b128 v30, v[56:59] offset:6144
    ds_write_b128 v30, v[60:63] offset:7168
    s_waitcnt lgkmcnt(0)
    s_barrier
    s_lshl_b32 s87, s79, 15
    s_bfe_u32 s88, s74, 0x10001
    s_lshl_b32 s89, s88, 12
    s_add_u32 s87, s87, s89
    s_and_b32 s89, s74, 1
    s_lshl_b32 s92, s89, 11
    s_add_u32 s87, s87, s92
    v_add_u32 v30, s87, v1
    ds_read_b128 v[64:67], v30 offset:0
    ds_read_b128 v[68:71], v30 offset:1024
    ds_read_b128 v[72:75], v30 offset:8192
    ds_read_b128 v[76:79], v30 offset:9216
    ds_read_b128 v[80:83], v30 offset:16384
    ds_read_b128 v[84:87], v30 offset:17408
    ds_read_b128 v[88:91], v30 offset:24576
    ds_read_b128 v[92:95], v30 offset:25600
    s_add_u32 s87, s77, s79
    s_mul_i32 s87, s87, 28672
    s_lshl_b32 s92, s76, 7
    s_add_u32 s87, s87, s92
    s_lshl_b32 s88, s88, 6
    s_add_u32 s87, s87, s88
    s_lshl_b32 s89, s89, 5
    s_add_u32 s87, s87, s89
    v_and_b32 v31, 31, v0
    v_mul_u32_u24 v31, 896, v31
    v_lshrrev_b32 v136, 5, v0
    v_lshl_add_u32 v31, v136, 4, v31
    s_waitcnt lgkmcnt(4)
    v_add_f32 v64, v64, v72
    v_add_f32 v65, v65, v73
    v_add_f32 v66, v66, v74
    v_add_f32 v67, v67, v75
    v_add_f32 v68, v68, v76
    v_add_f32 v69, v69, v77
    v_add_f32 v70, v70, v78
    v_add_f32 v71, v71, v79
    s_waitcnt lgkmcnt(0)
    v_add_f32 v80, v80, v88
    v_add_f32 v81, v81, v89
    v_add_f32 v82, v82, v90
    v_add_f32 v83, v83, v91
    v_add_f32 v84, v84, v92
    v_add_f32 v85, v85, v93
    v_add_f32 v86, v86, v94
    v_add_f32 v87, v87, v95
    v_add_f32 v64, v64, v80
    v_add_f32 v65, v65, v81
    v_add_f32 v66, v66, v82
    v_add_f32 v67, v67, v83
    v_add_f32 v68, v68, v84
    v_add_f32 v69, v69, v85
    v_add_f32 v70, v70, v86
    v_add_f32 v71, v71, v87
    v_cvt_pk_bf16_f32 v96, v64, v65
    v_cvt_pk_bf16_f32 v97, v66, v67
    v_cvt_pk_bf16_f32 v98, v68, v69
    v_cvt_pk_bf16_f32 v99, v70, v71
    s_nop 0
    v_permlane32_swap_b32 v96, v98
    v_permlane32_swap_b32 v97, v99
    buffer_store_dwordx4 v[96:99], v31, s[60:63], s87 offen
    s_endpgm
PATH_B:
    s_add_u32 m0, s81, 0
    s_bfe_u32 s92, s13, 262144
    s_lshl_b32 s92, s92, 7
    buffer_load_dwordx4 v2, s[28:31], s92 offen lds
    buffer_load_dwordx4 v3, s[28:31], s92 offen offset:1024 lds
    s_add_u32 m0, s82, 0
    s_mul_i32 s92, s92, 1792
    buffer_load_dwordx4 v4, s[32:35], s92 offen lds
    buffer_load_dwordx4 v5, s[32:35], s92 offen offset:1024 lds
    s_add_u32 m0, s81, 4096
    s_bfe_u32 s92, s13, 262148
    s_lshl_b32 s92, s92, 7
    buffer_load_dwordx4 v2, s[28:31], s92 offen lds
    buffer_load_dwordx4 v3, s[28:31], s92 offen offset:1024 lds
    s_add_u32 m0, s82, 8192
    s_mul_i32 s92, s92, 1792
    buffer_load_dwordx4 v4, s[32:35], s92 offen lds
    buffer_load_dwordx4 v5, s[32:35], s92 offen offset:1024 lds
    s_mov_b64 s[40:41], s[24:25]
    s_mov_b32 s42, 13631488
    s_mov_b32 s43, 0x20000
    s_mov_b64 s[44:45], s[24:25]
    s_cmp_eq_u32 s34, 0
    s_cselect_b32 s46, 0, 13631488
    s_mov_b32 s47, 0x20000
    s_cmp_lt_u32 s76, 7
    s_cselect_b32 s88, -1, 0
    s_mov_b64 s[48:49], s[24:25]
    s_and_b32 s50, s88, 13631488
    s_mov_b32 s51, 0x20000
    s_lshl_b32 s87, s76, 7
    s_add_u32 s52, s16, s87
    s_addc_u32 s53, s17, 0
    s_sub_u32 s54, 1605632, s87
    s_and_b32 s54, s54, s88
    s_mov_b32 s55, 0x20000
    s_add_u32 s56, s10, s87
    s_addc_u32 s57, s11, 0
    s_sub_u32 s58, 401408, s87
    s_and_b32 s58, s58, s88
    s_mov_b32 s59, 0x20000
    s_mov_b64 s[60:61], s[20:21]
    s_and_b32 s62, s88, 1835008
    s_mov_b32 s63, 0x20000
    s_mul_i32 s87, s73, 1568
    s_add_u32 s64, s8, s87
    s_addc_u32 s65, s9, 0
    s_mov_b32 s66, 1568
    s_mov_b32 s67, 0x20000
    s_bfe_u32 s36, s13, 262144
    s_lshl_b32 s36, s36, 7
    s_bfe_u32 s37, s13, 262148
    s_lshl_b32 s37, s37, 7
    s_bfe_u32 s38, s13, 262152
    s_lshl_b32 s38, s38, 7
    s_bfe_u32 s39, s13, 262156
    s_lshl_b32 s39, s39, 7
    s_bfe_u32 s68, s13, 262160
    s_lshl_b32 s68, s68, 7
    s_bfe_u32 s69, s13, 262164
    s_lshl_b32 s69, s69, 7
    s_bfe_u32 s70, s13, 262168
    s_lshl_b32 s70, s70, 7
    s_add_u32 m0, s81, 8192
    s_nop 0
    buffer_load_dwordx4 v2, s[28:31], s38 offen lds
    buffer_load_dwordx4 v3, s[28:31], s38 offen offset:1024 lds
    s_add_u32 m0, s82, 16384
    s_mul_i32 s92, s38, 1792
    buffer_load_dwordx4 v4, s[32:35], s92 offen lds
    buffer_load_dwordx4 v5, s[32:35], s92 offen offset:1024 lds
    v_and_b32 v120, 31, v0
    v_lshrrev_b32 v121, 5, v0
    v_lshrrev_b32 v126, 1, v120
    v_and_b32 v126, 7, v126
    v_xor_b32 v126, v126, v121
    v_lshlrev_b32 v126, 4, v126
    v_lshl_add_u32 v126, v120, 7, v126
    v_add_u32 v7, s80, v126
    v_xor_b32 v8, 32, v126
    v_add_u32 v8, s80, v8
    v_xor_b32 v9, 64, v126
    v_add_u32 v9, s80, v9
    v_xor_b32 v10, 96, v126
    v_add_u32 v10, s80, v10
    v_bfe_u32 v122, v0, 4, 1
    v_bfe_u32 v123, v0, 2, 2
    v_and_b32 v124, 3, v0
    v_lshrrev_b32 v125, 1, v124
    v_lshl_add_u32 v125, v122, 1, v125
    v_lshrrev_b32 v126, 1, v123
    v_lshlrev_b32 v126, 2, v126
    v_xor_b32 v125, v125, v126
    v_lshlrev_b32 v125, 4, v125
    v_and_b32 v126, 1, v124
    v_lshl_add_u32 v125, v126, 3, v125
    v_lshl_add_u32 v126, v121, 3, v123
    v_lshl_add_u32 v126, v126, 7, v125
    v_mov_b32 v13, v126
    v_xor_b32 v14, 64, v126
    v_add_u32 v15, 57344, v13
    v_add_u32 v16, 57344, v14
    v_add_u32 v11, 114688, v13
    v_add_u32 v12, 114688, v14
    v_lshl_add_u32 v126, v121, 2, v123
    v_lshl_add_u32 v126, v126, 7, v125
    v_add_u32 v22, s80, v126
    s_mul_i32 s95, s78, 12288
    s_add_u32 s95, s95, 114688
    v_add_u32 v20, s95, v126
    v_xor_b32 v126, 64, v126
    v_add_u32 v23, s80, v126
    v_add_u32 v21, s95, v126
    v_lshlrev_b32 v127, 3, v124
    v_lshl_add_u32 v127, v122, 5, v127
    v_lshl_add_u32 v126, v121, 3, v123
    v_lshl_add_u32 v18, v126, 6, v127
    v_add_u32 v19, 57344, v18
    v_add_u32 v17, 114688, v18
    v_mul_u32_u24 v24, 136, v120
    v_lshl_add_u32 v24, v121, 3, v24
    v_add_u32 v24, s80, v24
    v_lshl_add_u32 v126, v121, 2, v123
    s_lshr_b32 s87, s78, 1
    s_lshl_b32 s87, s87, 6
    v_mul_u32_u24 v25, 136, v126
    v_add_u32 v25, v25, v127
    v_add_u32 v25, s87, v25
    v_mul_u32_u24 v139, 56, v126
    v_add_u32 v139, v139, v127
    v_add_u32 v139, 26624, v139
    v_cmp_le_u32 s[96:97], 32, v0
    v_cmp_eq_u32 s[98:99], 28, v120
    v_and_b32 v26, 15, v0
    v_lshlrev_b32 v26, 7, v26
    v_min_u32 v141, 47, v0
    v_lshlrev_b32 v141, 7, v141
    s_mul_i32 s94, s73, 28672
    s_lshl_b32 s87, s78, 10
    s_add_u32 s94, s94, s87
    s_add_u32 s94, s94, 65536
    s_add_u32 s88, s79, 1
    s_mul_i32 s88, s88, 458752
    s_add_u32 s83, s94, s88
    s_mul_i32 s93, s79, 28672
    s_add_u32 s93, s93, s87
    s_add_u32 s93, s93, 114688
    s_lshl2_add_u32 s89, s72, s78
    s_mul_i32 s85, s89, 147456
    s_add_u32 s85, s85, 4194304
    s_lshl_b32 s84, s84, 12
    s_add_u32 s84, s84, s85
    s_lshl_b32 s86, s73, 16
    s_add_u32 s86, s86, s87
    s_add_u32 s86, s86, 2097152
    s_lshr_b32 s77, s73, 3
    s_lshl_b32 s77, s77, 1
    s_lshl2_add_u32 s77, s72, s77
    s_mov_b32 s90, 0x3fb8aa3b
    s_mul_i32 s95, s73, 6144
    s_lshl_b32 s87, s74, 11
    s_add_u32 s87, s87, s95
    s_lshl_b32 s21, s72, 7
    s_add_u32 s21, s21, s87
    s_add_u32 s21, s21, 1572864
    s_cmp_ge_u32 s74, 3
    s_cselect_b32 s21, 2147483648, s21
    s_mov_b32 s27, 0xbfb8aa3b
    s_waitcnt vmcnt(12)
    v_and_b32 v136, 3, v0
    v_cmp_eq_u32 vcc, 3, v136
    s_cmp_eq_u32 s74, 0
    s_cselect_b32 s89, 0xffff, 0
    v_mov_b32 v137, 0
    v_and_b32 v112, s89, v112
    v_cndmask_b32 v106, v106, v112, vcc
    v_cndmask_b32 v107, v107, v137, vcc
    v_and_b32 v113, s89, v113
    v_cndmask_b32 v110, v110, v113, vcc
    v_cndmask_b32 v111, v111, v137, vcc
    s_lshl4_add_u32 s87, s74, s73
    s_mul_i32 s87, s87, 28672
    s_mul_i32 s88, s72, 1792
    s_add_u32 s87, s87, s88
    s_add_u32 s87, s87, 65536
    buffer_store_dwordx4 v[104:107], v116, s[40:43], s87 offen sc1
    buffer_store_dwordx4 v[108:111], v117, s[40:43], s87 offen sc1
    s_nop 0
    v_mov_b32 v104, -1
    v_mov_b32 v105, -1
    v_mov_b32 v106, -1
    v_mov_b32 v107, -1
    s_lshl4_add_u32 s87, s73, s72
    s_lshl_b32 s87, s87, 12
    s_add_u32 s87, s87, 2097152
    s_lshl_b32 s88, s74, 10
    s_add_u32 s88, s88, s87
    s_cmp_ge_u32 s74, 3
    s_cselect_b32 s88, 2147483648, s88
    s_cselect_b32 s87, 2147483648, s87
    buffer_store_dwordx4 v[104:107], v1, s[40:43], s88 offen sc1
    buffer_store_dwordx4 v[104:107], v1, s[40:43], s87 offen offset:3072 sc1
    s_waitcnt vmcnt(12)
    s_barrier
    ds_read_b128 a[0:3], v7 offset:0
    ds_read_b128 a[4:7], v8 offset:0
    ds_read_b128 a[8:11], v9 offset:0
    ds_read_b128 a[12:15], v10 offset:0
    ds_read_b64_tr_b16 v[64:65], v11 offset:0
    ds_read_b64_tr_b16 v[66:67], v11 offset:512
    ds_read_b64_tr_b16 v[68:69], v12 offset:0
    ds_read_b64_tr_b16 v[70:71], v12 offset:512
    ds_read_b64_tr_b16 v[72:73], v11 offset:2048
    ds_read_b64_tr_b16 v[74:75], v11 offset:2560
    ds_read_b64_tr_b16 v[76:77], v12 offset:2048
    ds_read_b64_tr_b16 v[78:79], v12 offset:2560
    ds_read_b64_tr_b16 v[80:81], v11 offset:4096
    ds_read_b64_tr_b16 v[82:83], v11 offset:4608
    ds_read_b64_tr_b16 v[84:85], v12 offset:4096
    ds_read_b64_tr_b16 v[86:87], v12 offset:4608
    s_waitcnt lgkmcnt(8)
    v_mfma_f32_32x32x16_bf16 v[32:47], v[64:67], a[0:3], 0
    ds_read_b64_tr_b16 v[88:89], v11 offset:6144
    ds_read_b64_tr_b16 v[90:91], v11 offset:6656
    v_mfma_f32_32x32x16_bf16 v[48:63], v[68:71], a[0:3], 0
    ds_read_b64_tr_b16 v[92:93], v12 offset:6144
    ds_read_b64_tr_b16 v[94:95], v12 offset:6656
    s_waitcnt vmcnt(8)
    s_barrier
    ds_read_b128 a[16:19], v7 offset:4096
    ds_read_b128 a[20:23], v8 offset:4096
    ds_read_b128 a[24:27], v9 offset:4096
    ds_read_b128 a[28:31], v10 offset:4096
    s_waitcnt lgkmcnt(12)
    v_mfma_f32_32x32x16_bf16 v[32:47], v[72:75], a[4:7], v[32:47]
    ds_read_b64_tr_b16 v[64:65], v11 offset:8192
    ds_read_b64_tr_b16 v[66:67], v11 offset:8704
    v_mfma_f32_32x32x16_bf16 v[48:63], v[76:79], a[4:7], v[48:63]
    ds_read_b64_tr_b16 v[68:69], v12 offset:8192
    ds_read_b64_tr_b16 v[70:71], v12 offset:8704
    s_add_u32 m0, s81, 12288
    s_nop 0
    buffer_load_dwordx4 v2, s[28:31], s39 offen lds
    buffer_load_dwordx4 v3, s[28:31], s39 offen offset:1024 lds
    s_waitcnt lgkmcnt(12)
    v_mfma_f32_32x32x16_bf16 v[32:47], v[80:83], a[8:11], v[32:47]
    ds_read_b64_tr_b16 v[72:73], v11 offset:10240
    ds_read_b64_tr_b16 v[74:75], v11 offset:10752
    v_mfma_f32_32x32x16_bf16 v[48:63], v[84:87], a[8:11], v[48:63]
    ds_read_b64_tr_b16 v[76:77], v12 offset:10240
    ds_read_b64_tr_b16 v[78:79], v12 offset:10752
    s_add_u32 m0, s82, 24576
    s_mul_i32 s92, s39, 1792
    buffer_load_dwordx4 v4, s[32:35], s92 offen lds
    buffer_load_dwordx4 v5, s[32:35], s92 offen offset:1024 lds
    s_waitcnt lgkmcnt(12)
    v_mfma_f32_32x32x16_bf16 v[32:47], v[88:91], a[12:15], v[32:47]
    ds_read_b64_tr_b16 v[80:81], v11 offset:12288
    ds_read_b64_tr_b16 v[82:83], v11 offset:12800
    v_mfma_f32_32x32x16_bf16 v[48:63], v[92:95], a[12:15], v[48:63]
    ds_read_b64_tr_b16 v[84:85], v12 offset:12288
    ds_read_b64_tr_b16 v[86:87], v12 offset:12800
    v_mov_b32 v128, 0
    global_load_dword v27, v128, s[22:23] sc1
    s_waitcnt lgkmcnt(8)
    v_mfma_f32_32x32x16_bf16 v[32:47], v[64:67], a[16:19], v[32:47]
    ds_read_b64_tr_b16 v[88:89], v11 offset:14336
    ds_read_b64_tr_b16 v[90:91], v11 offset:14848
    v_mfma_f32_32x32x16_bf16 v[48:63], v[68:71], a[16:19], v[48:63]
    ds_read_b64_tr_b16 v[92:93], v12 offset:14336
    ds_read_b64_tr_b16 v[94:95], v12 offset:14848
    s_waitcnt vmcnt(9)
    s_barrier
    ds_read_b128 a[32:35], v7 offset:8192
    ds_read_b128 a[36:39], v8 offset:8192
    ds_read_b128 a[40:43], v9 offset:8192
    ds_read_b128 a[44:47], v10 offset:8192
    s_waitcnt lgkmcnt(12)
    v_mfma_f32_32x32x16_bf16 v[32:47], v[72:75], a[20:23], v[32:47]
    ds_read_b64_tr_b16 v[64:65], v11 offset:16384
    ds_read_b64_tr_b16 v[66:67], v11 offset:16896
    v_mfma_f32_32x32x16_bf16 v[48:63], v[76:79], a[20:23], v[48:63]
    ds_read_b64_tr_b16 v[68:69], v12 offset:16384
    ds_read_b64_tr_b16 v[70:71], v12 offset:16896
    s_add_u32 m0, s81, 16384
    s_nop 0
    buffer_load_dwordx4 v2, s[28:31], s68 offen lds
    buffer_load_dwordx4 v3, s[28:31], s68 offen offset:1024 lds
    s_waitcnt lgkmcnt(12)
    v_mfma_f32_32x32x16_bf16 v[32:47], v[80:83], a[24:27], v[32:47]
    ds_read_b64_tr_b16 v[72:73], v11 offset:18432
    ds_read_b64_tr_b16 v[74:75], v11 offset:18944
    v_mfma_f32_32x32x16_bf16 v[48:63], v[84:87], a[24:27], v[48:63]
    ds_read_b64_tr_b16 v[76:77], v12 offset:18432
    ds_read_b64_tr_b16 v[78:79], v12 offset:18944
    s_add_u32 m0, s82, 32768
    s_mul_i32 s92, s68, 1792
    buffer_load_dwordx4 v4, s[32:35], s92 offen lds
    buffer_load_dwordx4 v5, s[32:35], s92 offen offset:1024 lds
    s_waitcnt lgkmcnt(12)
    v_mfma_f32_32x32x16_bf16 v[32:47], v[88:91], a[28:31], v[32:47]
    ds_read_b64_tr_b16 v[80:81], v11 offset:20480
    ds_read_b64_tr_b16 v[82:83], v11 offset:20992
    v_mfma_f32_32x32x16_bf16 v[48:63], v[92:95], a[28:31], v[48:63]
    ds_read_b64_tr_b16 v[84:85], v12 offset:20480
    ds_read_b64_tr_b16 v[86:87], v12 offset:20992
    s_add_u32 m0, s80, 2048
    s_mul_i32 s92, s70, 1792
    buffer_load_dwordx4 v4, s[32:35], s92 offen lds
    buffer_load_dwordx4 v5, s[32:35], s92 offen offset:1024 lds
    s_waitcnt lgkmcnt(8)
    v_mfma_f32_32x32x16_bf16 v[32:47], v[64:67], a[32:35], v[32:47]
    ds_read_b64_tr_b16 v[88:89], v11 offset:22528
    ds_read_b64_tr_b16 v[90:91], v11 offset:23040
    v_mfma_f32_32x32x16_bf16 v[48:63], v[68:71], a[32:35], v[48:63]
    ds_read_b64_tr_b16 v[92:93], v12 offset:22528
    ds_read_b64_tr_b16 v[94:95], v12 offset:23040
    s_waitcnt vmcnt(7)
    s_barrier
    ds_read_b128 a[48:51], v7 offset:12288
    ds_read_b128 a[52:55], v8 offset:12288
    ds_read_b128 a[56:59], v9 offset:12288
    ds_read_b128 a[60:63], v10 offset:12288
    s_waitcnt lgkmcnt(12)
    v_mfma_f32_32x32x16_bf16 v[32:47], v[72:75], a[36:39], v[32:47]
    ds_read_b64_tr_b16 v[64:65], v11 offset:24576
    ds_read_b64_tr_b16 v[66:67], v11 offset:25088
    v_mfma_f32_32x32x16_bf16 v[48:63], v[76:79], a[36:39], v[48:63]
    ds_read_b64_tr_b16 v[68:69], v12 offset:24576
    ds_read_b64_tr_b16 v[70:71], v12 offset:25088
    s_add_u32 m0, s81, 20480
    s_nop 0
    buffer_load_dwordx4 v2, s[28:31], s69 offen lds
    buffer_load_dwordx4 v3, s[28:31], s69 offen offset:1024 lds
    s_waitcnt lgkmcnt(12)
    v_mfma_f32_32x32x16_bf16 v[32:47], v[80:83], a[40:43], v[32:47]
    ds_read_b64_tr_b16 v[72:73], v11 offset:26624
    ds_read_b64_tr_b16 v[74:75], v11 offset:27136
    v_mfma_f32_32x32x16_bf16 v[48:63], v[84:87], a[40:43], v[48:63]
    ds_read_b64_tr_b16 v[76:77], v12 offset:26624
    ds_read_b64_tr_b16 v[78:79], v12 offset:27136
    s_add_u32 m0, s82, 40960
    s_mul_i32 s92, s69, 1792
    buffer_load_dwordx4 v4, s[32:35], s92 offen lds
    buffer_load_dwordx4 v5, s[32:35], s92 offen offset:1024 lds
    s_waitcnt lgkmcnt(12)
    v_mfma_f32_32x32x16_bf16 v[32:47], v[88:91], a[44:47], v[32:47]
    ds_read_b64_tr_b16 v[80:81], v11 offset:28672
    ds_read_b64_tr_b16 v[82:83], v11 offset:29184
    v_mfma_f32_32x32x16_bf16 v[48:63], v[92:95], a[44:47], v[48:63]
    ds_read_b64_tr_b16 v[84:85], v12 offset:28672
    ds_read_b64_tr_b16 v[86:87], v12 offset:29184
    s_waitcnt vmcnt(10)
    v_cmp_eq_u32 vcc, 0, v27
    s_cbranch_vccz NRD_17
    s_mov_b32 s91, 0x40000
NR_16:
    global_load_dword v27, v128, s[22:23] sc1
    s_waitcnt vmcnt(0)
    v_cmp_eq_u32 vcc, 0, v27
    s_cbranch_vccz NRD_17
    s_sub_u32 s91, s91, 1
    s_cmp_eq_u32 s91, 0
    s_cbranch_scc1 NRD_17
    s_sleep 1
    s_branch NR_16
NRD_17:
    v_readfirstlane_b32 s22, v27
    s_nop 0
    s_mov_b32 s23, s22
    s_mov_b64 exec, 1
    buffer_store_dword v27, off, s[40:43], s21 sc1
    s_mov_b64 exec, -1
    s_waitcnt lgkmcnt(8)
    v_mfma_f32_32x32x16_bf16 v[32:47], v[64:67], a[48:51], v[32:47]
    ds_read_b64_tr_b16 v[88:89], v11 offset:30720
    ds_read_b64_tr_b16 v[90:91], v11 offset:31232
    v_mfma_f32_32x32x16_bf16 v[48:63], v[68:71], a[48:51], v[48:63]
    ds_read_b64_tr_b16 v[92:93], v12 offset:30720
    ds_read_b64_tr_b16 v[94:95], v12 offset:31232
    s_waitcnt vmcnt(7)
    s_barrier
    ds_read_b128 a[64:67], v7 offset:16384
    ds_read_b128 a[68:71], v8 offset:16384
    ds_read_b128 a[72:75], v9 offset:16384
    ds_read_b128 a[76:79], v10 offset:16384
    s_waitcnt lgkmcnt(12)
    v_mfma_f32_32x32x16_bf16 v[32:47], v[72:75], a[52:55], v[32:47]
    ds_read_b64_tr_b16 v[64:65], v11 offset:32768
    ds_read_b64_tr_b16 v[66:67], v11 offset:33280
    v_mfma_f32_32x32x16_bf16 v[48:63], v[76:79], a[52:55], v[48:63]
    ds_read_b64_tr_b16 v[68:69], v12 offset:32768
    ds_read_b64_tr_b16 v[70:71], v12 offset:33280
    s_add_u32 m0, s81, 24576
    s_nop 0
    buffer_load_dwordx4 v2, s[28:31], s70 offen lds
    buffer_load_dwordx4 v3, s[28:31], s70 offen offset:1024 lds
    s_waitcnt lgkmcnt(12)
    v_mfma_f32_32x32x16_bf16 v[32:47], v[80:83], a[56:59], v[32:47]
    ds_read_b64_tr_b16 v[72:73], v11 offset:34816
    ds_read_b64_tr_b16 v[74:75], v11 offset:35328
    v_mfma_f32_32x32x16_bf16 v[48:63], v[84:87], a[56:59], v[48:63]
    ds_read_b64_tr_b16 v[76:77], v12 offset:34816
    ds_read_b64_tr_b16 v[78:79], v12 offset:35328
    s_waitcnt lgkmcnt(12)
    v_mfma_f32_32x32x16_bf16 v[32:47], v[88:91], a[60:63], v[32:47]
    ds_read_b64_tr_b16 v[80:81], v11 offset:36864
    ds_read_b64_tr_b16 v[82:83], v11 offset:37376
    v_mfma_f32_32x32x16_bf16 v[48:63], v[92:95], a[60:63], v[48:63]
    ds_read_b64_tr_b16 v[84:85], v12 offset:36864
    ds_read_b64_tr_b16 v[86:87], v12 offset:37376
    s_waitcnt lgkmcnt(8)
    v_mfma_f32_32x32x16_bf16 v[32:47], v[64:67], a[64:67], v[32:47]
    ds_read_b64_tr_b16 v[88:89], v11 offset:38912
    ds_read_b64_tr_b16 v[90:91], v11 offset:39424
    v_mfma_f32_32x32x16_bf16 v[48:63], v[68:71], a[64:67], v[48:63]
    ds_read_b64_tr_b16 v[92:93], v12 offset:38912
    ds_read_b64_tr_b16 v[94:95], v12 offset:39424
    s_waitcnt vmcnt(3)
    s_barrier
    ds_read_b128 a[80:83], v7 offset:20480
    ds_read_b128 a[84:87], v8 offset:20480
    ds_read_b128 a[88:91], v9 offset:20480
    ds_read_b128 a[92:95], v10 offset:20480
    s_waitcnt lgkmcnt(12)
    v_mfma_f32_32x32x16_bf16 v[32:47], v[72:75], a[68:71], v[32:47]
    ds_read_b64_tr_b16 v[64:65], v11 offset:40960
    ds_read_b64_tr_b16 v[66:67], v11 offset:41472
    v_mfma_f32_32x32x16_bf16 v[48:63], v[76:79], a[68:71], v[48:63]
    ds_read_b64_tr_b16 v[68:69], v12 offset:40960
    ds_read_b64_tr_b16 v[70:71], v12 offset:41472
    s_waitcnt lgkmcnt(12)
    v_mfma_f32_32x32x16_bf16 v[32:47], v[80:83], a[72:75], v[32:47]
    ds_read_b64_tr_b16 v[72:73], v11 offset:43008
    ds_read_b64_tr_b16 v[74:75], v11 offset:43520
    v_mfma_f32_32x32x16_bf16 v[48:63], v[84:87], a[72:75], v[48:63]
    ds_read_b64_tr_b16 v[76:77], v12 offset:43008
    ds_read_b64_tr_b16 v[78:79], v12 offset:43520
    s_waitcnt lgkmcnt(12)
    v_mfma_f32_32x32x16_bf16 v[32:47], v[88:91], a[76:79], v[32:47]
    ds_read_b64_tr_b16 v[80:81], v11 offset:45056
    ds_read_b64_tr_b16 v[82:83], v11 offset:45568
    v_mfma_f32_32x32x16_bf16 v[48:63], v[92:95], a[76:79], v[48:63]
    ds_read_b64_tr_b16 v[84:85], v12 offset:45056
    ds_read_b64_tr_b16 v[86:87], v12 offset:45568
    s_waitcnt lgkmcnt(8)
    v_mfma_f32_32x32x16_bf16 v[32:47], v[64:67], a[80:83], v[32:47]
    ds_read_b64_tr_b16 v[88:89], v11 offset:47104
    ds_read_b64_tr_b16 v[90:91], v11 offset:47616
    v_mfma_f32_32x32x16_bf16 v[48:63], v[68:71], a[80:83], v[48:63]
    ds_read_b64_tr_b16 v[92:93], v12 offset:47104
    ds_read_b64_tr_b16 v[94:95], v12 offset:47616
    s_waitcnt vmcnt(0)
    s_barrier
    ds_read_b128 a[96:99], v7 offset:24576
    ds_read_b128 a[100:103], v8 offset:24576
    ds_read_b128 a[104:107], v9 offset:24576
    ds_read_b128 a[108:111], v10 offset:24576
    s_waitcnt lgkmcnt(12)
    v_mfma_f32_32x32x16_bf16 v[32:47], v[72:75], a[84:87], v[32:47]
    ds_read_b64_tr_b16 v[64:65], v13 offset:2048
    ds_read_b64_tr_b16 v[66:67], v13 offset:2560
    v_mfma_f32_32x32x16_bf16 v[48:63], v[76:79], a[84:87], v[48:63]
    ds_read_b64_tr_b16 v[68:69], v14 offset:2048
    ds_read_b64_tr_b16 v[70:71], v14 offset:2560
    s_waitcnt lgkmcnt(12)
    v_mfma_f32_32x32x16_bf16 v[32:47], v[80:83], a[88:91], v[32:47]
    ds_read_b64_tr_b16 v[72:73], v13 offset:30720
    ds_read_b64_tr_b16 v[74:75], v13 offset:31232
    v_mfma_f32_32x32x16_bf16 v[48:63], v[84:87], a[88:91], v[48:63]
    ds_read_b64_tr_b16 v[76:77], v14 offset:30720
    ds_read_b64_tr_b16 v[78:79], v14 offset:31232
    s_waitcnt lgkmcnt(12)
    v_mfma_f32_32x32x16_bf16 v[32:47], v[88:91], a[92:95], v[32:47]
    ds_read_b64_tr_b16 v[80:81], v15 offset:2048
    ds_read_b64_tr_b16 v[82:83], v15 offset:2560
    v_mfma_f32_32x32x16_bf16 v[48:63], v[92:95], a[92:95], v[48:63]
    ds_read_b64_tr_b16 v[84:85], v16 offset:2048
    ds_read_b64_tr_b16 v[86:87], v16 offset:2560
    s_waitcnt lgkmcnt(8)
    v_mfma_f32_32x32x16_bf16 v[32:47], v[64:67], a[96:99], v[32:47]
    ds_read_b64_tr_b16 v[88:89], v15 offset:30720
    ds_read_b64_tr_b16 v[90:91], v15 offset:31232
    v_mfma_f32_32x32x16_bf16 v[48:63], v[68:71], a[96:99], v[48:63]
    ds_read_b64_tr_b16 v[92:93], v16 offset:30720
    ds_read_b64_tr_b16 v[94:95], v16 offset:31232
    s_waitcnt lgkmcnt(8)
    v_mfma_f32_32x32x16_bf16 v[32:47], v[72:75], a[100:103], v[32:47]
    v_mfma_f32_32x32x16_bf16 v[48:63], v[76:79], a[100:103], v[48:63]
    s_waitcnt lgkmcnt(4)
    v_mfma_f32_32x32x16_bf16 v[32:47], v[80:83], a[104:107], v[32:47]
    v_mfma_f32_32x32x16_bf16 v[48:63], v[84:87], a[104:107], v[48:63]
    s_waitcnt lgkmcnt(0)
    v_mfma_f32_32x32x16_bf16 v[32:47], v[88:91], a[108:111], v[32:47]
    v_mfma_f32_32x32x16_bf16 v[48:63], v[92:95], a[108:111], v[48:63]
    s_waitcnt lgkmcnt(0)
    s_barrier
    v_mov_b32 v64, -1
    v_mov_b32 v65, -1
    v_mov_b32 v66, -1
    v_mov_b32 v67, -1
    s_lshl_b32 s87, s73, 11
    s_add_u32 s87, s87, s85
    s_add_u32 s87, s87, 114688
    buffer_store_dwordx4 v[64:67], v1, s[40:43], s87 offen offset:0 sc1
    buffer_store_dwordx4 v[64:67], v1, s[40:43], s87 offen offset:1024 sc1
    v_mul_f32 v104, s27, v32
    v_mul_f32 v105, s27, v33
    v_mul_f32 v106, s27, v34
    v_mul_f32 v107, s27, v35
    v_exp_f32 v104, v104
    v_exp_f32 v105, v105
    v_exp_f32 v106, v106
    v_exp_f32 v107, v107
    v_add_f32 v104, 1.0, v104
    v_add_f32 v105, 1.0, v105
    v_add_f32 v106, 1.0, v106
    v_add_f32 v107, 1.0, v107
    v_rcp_f32 v104, v104
    v_rcp_f32 v105, v105
    v_rcp_f32 v106, v106
    v_rcp_f32 v107, v107
    v_mul_f32 v104, v32, v104
    v_mul_f32 v105, v33, v105
    v_mul_f32 v106, v34, v106
    v_mul_f32 v107, v35, v107
    v_cvt_pk_bf16_f32 v120, v104, v105
    v_cvt_pk_bf16_f32 v121, v106, v107
    v_mul_f32 v108, s27, v36
    v_mul_f32 v109, s27, v37
    v_mul_f32 v110, s27, v38
    v_mul_f32 v111, s27, v39
    v_exp_f32 v108, v108
    v_exp_f32 v109, v109
    v_exp_f32 v110, v110
    v_exp_f32 v111, v111
    v_add_f32 v108, 1.0, v108
    v_add_f32 v109, 1.0, v109
    v_add_f32 v110, 1.0, v110
    v_add_f32 v111, 1.0, v111
    v_rcp_f32 v108, v108
    v_rcp_f32 v109, v109
    v_rcp_f32 v110, v110
    v_rcp_f32 v111, v111
    v_mul_f32 v108, v36, v108
    v_mul_f32 v109, v37, v109
    v_mul_f32 v110, v38, v110
    v_mul_f32 v111, v39, v111
    v_cvt_pk_bf16_f32 v122, v108, v109
    v_cvt_pk_bf16_f32 v123, v110, v111
    buffer_store_dwordx4 v[120:123], v1, s[44:47], s84 offen offset:0 sc1
    v_mul_f32 v112, s27, v40
    v_mul_f32 v113, s27, v41
    v_mul_f32 v114, s27, v42
    v_mul_f32 v115, s27, v43
    v_exp_f32 v112, v112
    v_exp_f32 v113, v113
    v_exp_f32 v114, v114
    v_exp_f32 v115, v115
    v_add_f32 v112, 1.0, v112
    v_add_f32 v113, 1.0, v113
    v_add_f32 v114, 1.0, v114
    v_add_f32 v115, 1.0, v115
    v_rcp_f32 v112, v112
    v_rcp_f32 v113, v113
    v_rcp_f32 v114, v114
    v_rcp_f32 v115, v115
    v_mul_f32 v112, v40, v112
    v_mul_f32 v113, v41, v113
    v_mul_f32 v114, v42, v114
    v_mul_f32 v115, v43, v115
    v_cvt_pk_bf16_f32 v124, v112, v113
    v_cvt_pk_bf16_f32 v125, v114, v115
    v_mul_f32 v116, s27, v44
    v_mul_f32 v117, s27, v45
    v_mul_f32 v118, s27, v46
    v_mul_f32 v119, s27, v47
    v_exp_f32 v116, v116
    s_barrier
    v_exp_f32 v117, v117
    v_exp_f32 v118, v118
    v_exp_f32 v119, v119
    v_add_f32 v116, 1.0, v116
    v_add_f32 v117, 1.0, v117
    v_add_f32 v118, 1.0, v118
    v_add_f32 v119, 1.0, v119
    v_rcp_f32 v116, v116
    v_rcp_f32 v117, v117
    v_rcp_f32 v118, v118
    v_rcp_f32 v119, v119
    v_mul_f32 v116, v44, v116
    v_mul_f32 v117, v45, v117
    v_mul_f32 v118, v46, v118
    v_mul_f32 v119, v47, v119
    v_cvt_pk_bf16_f32 v126, v116, v117
    v_cvt_pk_bf16_f32 v127, v118, v119
    buffer_store_dwordx4 v[124:127], v1, s[44:47], s84 offen offset:1024 sc1
    v_mul_f32 v104, s27, v48
    v_mul_f32 v105, s27, v49
    v_mul_f32 v106, s27, v50
    v_mul_f32 v107, s27, v51
    v_exp_f32 v104, v104
    v_exp_f32 v105, v105
    v_exp_f32 v106, v106
    v_exp_f32 v107, v107
    v_add_f32 v104, 1.0, v104
    v_add_f32 v105, 1.0, v105
    v_add_f32 v106, 1.0, v106
    v_add_f32 v107, 1.0, v107
    v_rcp_f32 v104, v104
    v_rcp_f32 v105, v105
    v_rcp_f32 v106, v106
    v_rcp_f32 v107, v107
    v_mul_f32 v104, v48, v104
    v_mul_f32 v105, v49, v105
    v_mul_f32 v106, v50, v106
    v_mul_f32 v107, v51, v107
    v_cvt_pk_bf16_f32 v120, v104, v105
    v_cvt_pk_bf16_f32 v121, v106, v107
    v_mul_f32 v108, s27, v52
    v_mul_f32 v109, s27, v53
    v_mul_f32 v110, s27, v54
    v_mul_f32 v111, s27, v55
    v_exp_f32 v108, v108
    v_exp_f32 v109, v109
    v_exp_f32 v110, v110
    v_exp_f32 v111, v111
    v_add_f32 v108, 1.0, v108
    v_add_f32 v109, 1.0, v109
    v_add_f32 v110, 1.0, v110
    v_add_f32 v111, 1.0, v111
    v_rcp_f32 v108, v108
    v_rcp_f32 v109, v109
    s_barrier
    v_rcp_f32 v110, v110
    v_rcp_f32 v111, v111
    v_mul_f32 v108, v52, v108
    v_mul_f32 v109, v53, v109
    v_mul_f32 v110, v54, v110
    v_mul_f32 v111, v55, v111
    v_cvt_pk_bf16_f32 v122, v108, v109
    v_cvt_pk_bf16_f32 v123, v110, v111
    buffer_store_dwordx4 v[120:123], v1, s[44:47], s84 offen offset:2048 sc1
    v_mul_f32 v112, s27, v56
    v_mul_f32 v113, s27, v57
    v_mul_f32 v114, s27, v58
    v_mul_f32 v115, s27, v59
    v_exp_f32 v112, v112
    v_exp_f32 v113, v113
    v_exp_f32 v114, v114
    v_exp_f32 v115, v115
    v_add_f32 v112, 1.0, v112
    v_add_f32 v113, 1.0, v113
    v_add_f32 v114, 1.0, v114
    v_add_f32 v115, 1.0, v115
    v_rcp_f32 v112, v112
    v_rcp_f32 v113, v113
    v_rcp_f32 v114, v114
    v_rcp_f32 v115, v115
    v_mul_f32 v112, v56, v112
    v_mul_f32 v113, v57, v113
    v_mul_f32 v114, v58, v114
    v_mul_f32 v115, v59, v115
    v_cvt_pk_bf16_f32 v124, v112, v113
    v_cvt_pk_bf16_f32 v125, v114, v115
    v_mul_f32 v116, s27, v60
    v_mul_f32 v117, s27, v61
    v_mul_f32 v118, s27, v62
    v_mul_f32 v119, s27, v63
    v_exp_f32 v116, v116
    v_exp_f32 v117, v117
    v_exp_f32 v118, v118
    v_exp_f32 v119, v119
    v_add_f32 v116, 1.0, v116
    v_add_f32 v117, 1.0, v117
    v_add_f32 v118, 1.0, v118
    v_add_f32 v119, 1.0, v119
    v_rcp_f32 v116, v116
    v_rcp_f32 v117, v117
    v_rcp_f32 v118, v118
    v_rcp_f32 v119, v119
    v_mul_f32 v116, v60, v116
    v_mul_f32 v117, v61, v117
    v_mul_f32 v118, v62, v118
    v_mul_f32 v119, v63, v119
    v_cvt_pk_bf16_f32 v126, v116, v117
    v_cvt_pk_bf16_f32 v127, v118, v119
    buffer_store_dwordx4 v[124:127], v1, s[44:47], s84 offen offset:3072 sc1
    s_lshl2_add_u32 s89, s72, s78
    s_lshl4_add_u32 s89, s89, s73
    s_lshl_b32 s89, s89, 7
    s_lshl_b32 s87, s79, 17
    s_add_u32 s64, s89, s87
    s_add_u32 s64, s64, 1703936
    s_add_u32 s87, s77, s79
    s_lshl_b32 s65, s87, 11
    s_waitcnt vmcnt(0)
    s_mov_b64 exec, 1
    buffer_store_dword v27, off, s[40:43], s64 sc1
    s_mov_b64 exec, -1
    s_waitcnt lgkmcnt(0)
    s_barrier
    s_lshl_b32 s87, s78, 3
    s_cmp_lt_u32 s78, 3
    s_cselect_b32 s87, s87, 24
    s_mul_i32 s36, s87, 57344
    s_cselect_b32 s37, 2, 1
    s_lshl_b32 s67, s37, 12
    s_mul_i32 s37, s37, 57344
    s_mul_i32 s38, s78, 344064
    s_add_u32 s38, s38, 57344
    s_add_u32 s92, s77, s79
    s_mul_i32 s28, s92, 147456
    s_add_u32 s28, s28, 4194304
    s_lshl_b32 s87, s87, 12
    s_add_u32 s39, s28, s87
    s_mul_i32 s87, s78, 24576
    s_add_u32 s68, s28, s87
    s_add_u32 s68, s68, 4096
    s_lshl_b32 s87, s78, 13
    s_add_u32 s29, s28, s87
    s_add_u32 s29, s29, 114688
    s_mul_i32 s30, s78, 100352
    s_mul_i32 s35, s78, 12288
    s_add_u32 s35, s35, 114688
    s_add_u32 s87, s72, s76
    s_and_b32 s87, s87, 3
    s_lshl_b32 s87, s87, 2
    s_lshr_b32 s33, 0x32103210, s87
    s_lshr_b32 s34, 0x210210, s87
    ds_read_b64_tr_b16 v[64:65], v17 offset:28672
    ds_read_b64_tr_b16 v[66:67], v17 offset:28928
    ds_read_b64_tr_b16 v[68:69], v17 offset:29696
    ds_read_b64_tr_b16 v[70:71], v17 offset:29952
    ds_read_b64_tr_b16 v[72:73], v17 offset:30720
    ds_read_b64_tr_b16 v[74:75], v17 offset:30976
    ds_read_b64_tr_b16 v[76:77], v17 offset:31744
    ds_read_b64_tr_b16 v[78:79], v17 offset:32000
    s_waitcnt lgkmcnt(4)
    v_mfma_f32_32x32x16_bf16 v[88:103], a[0:3], v[64:67], 0
    ds_read_b64_tr_b16 v[80:81], v17 offset:32768
    ds_read_b64_tr_b16 v[82:83], v17 offset:33024
    v_mfma_f32_32x32x16_bf16 v[88:103], a[4:7], v[68:71], v[88:103]
    ds_read_b64_tr_b16 v[84:85], v17 offset:33792
    ds_read_b64_tr_b16 v[86:87], v17 offset:34048
    s_waitcnt lgkmcnt(4)
    v_mfma_f32_32x32x16_bf16 v[88:103], a[8:11], v[72:75], v[88:103]
    ds_read_b64_tr_b16 v[64:65], v17 offset:34816
    ds_read_b64_tr_b16 v[66:67], v17 offset:35072
    v_mfma_f32_32x32x16_bf16 v[88:103], a[12:15], v[76:79], v[88:103]
    ds_read_b64_tr_b16 v[68:69], v17 offset:35840
    ds_read_b64_tr_b16 v[70:71], v17 offset:36096
    s_waitcnt lgkmcnt(4)
    v_mfma_f32_32x32x16_bf16 v[88:103], a[16:19], v[80:83], v[88:103]
    ds_read_b64_tr_b16 v[72:73], v17 offset:36864
    ds_read_b64_tr_b16 v[74:75], v17 offset:37120
    v_mfma_f32_32x32x16_bf16 v[88:103], a[20:23], v[84:87], v[88:103]
    ds_read_b64_tr_b16 v[76:77], v17 offset:37888
    ds_read_b64_tr_b16 v[78:79], v17 offset:38144
    s_waitcnt lgkmcnt(4)
    v_mfma_f32_32x32x16_bf16 v[88:103], a[24:27], v[64:67], v[88:103]
    ds_read_b64_tr_b16 v[80:81], v17 offset:38912
    ds_read_b64_tr_b16 v[82:83], v17 offset:39168
    v_mfma_f32_32x32x16_bf16 v[88:103], a[28:31], v[68:71], v[88:103]
    ds_read_b64_tr_b16 v[84:85], v17 offset:39936
    ds_read_b64_tr_b16 v[86:87], v17 offset:40192
    s_waitcnt lgkmcnt(4)
    v_mfma_f32_32x32x16_bf16 v[88:103], a[32:35], v[72:75], v[88:103]
    ds_read_b64_tr_b16 v[64:65], v17 offset:40960
    ds_read_b64_tr_b16 v[66:67], v17 offset:41216
    v_mfma_f32_32x32x16_bf16 v[88:103], a[36:39], v[76:79], v[88:103]
    s_add_u32 m0, s80, 12288
    s_bfe_u32 s92, s34, 262144
    s_mul_i32 s92, s92, 114688
    s_add_u32 s92, s92, s38
    buffer_load_dwordx4 v6, s[52:55], s92 offen lds
    buffer_load_dwordx4 v140, s[52:55], s92 offen offset:1024 lds
    ds_read_b64_tr_b16 v[68:69], v17 offset:41984
    ds_read_b64_tr_b16 v[70:71], v17 offset:42240
    s_waitcnt lgkmcnt(4)
    v_mfma_f32_32x32x16_bf16 v[88:103], a[40:43], v[80:83], v[88:103]
    ds_read_b64_tr_b16 v[72:73], v17 offset:43008
    ds_read_b64_tr_b16 v[74:75], v17 offset:43264
    v_mfma_f32_32x32x16_bf16 v[88:103], a[44:47], v[84:87], v[88:103]
    ds_read_b64_tr_b16 v[76:77], v17 offset:44032
    ds_read_b64_tr_b16 v[78:79], v17 offset:44288
    s_waitcnt lgkmcnt(4)
    v_mfma_f32_32x32x16_bf16 v[88:103], a[48:51], v[64:67], v[88:103]
    ds_read_b64_tr_b16 v[80:81], v17 offset:45056
    ds_read_b64_tr_b16 v[82:83], v17 offset:45312
    v_mfma_f32_32x32x16_bf16 v[88:103], a[52:55], v[68:71], v[88:103]
    ds_read_b64_tr_b16 v[84:85], v17 offset:46080
    ds_read_b64_tr_b16 v[86:87], v17 offset:46336
    s_waitcnt lgkmcnt(4)
    v_mfma_f32_32x32x16_bf16 v[88:103], a[56:59], v[72:75], v[88:103]
    ds_read_b64_tr_b16 v[64:65], v17 offset:47104
    ds_read_b64_tr_b16 v[66:67], v17 offset:47360
    v_mfma_f32_32x32x16_bf16 v[88:103], a[60:63], v[76:79], v[88:103]
    s_add_u32 m0, s80, 16384
    s_bfe_u32 s92, s34, 262144
    s_mul_i32 s92, s92, 114688
    s_add_u32 s92, s92, s38
    s_add_u32 s92, s92, 14336
    buffer_load_dwordx4 v6, s[52:55], s92 offen lds
    buffer_load_dwordx4 v140, s[52:55], s92 offen offset:1024 lds
    ds_read_b64_tr_b16 v[68:69], v17 offset:48128
    ds_read_b64_tr_b16 v[70:71], v17 offset:48384
    s_waitcnt lgkmcnt(4)
    v_mfma_f32_32x32x16_bf16 v[88:103], a[64:67], v[80:83], v[88:103]
    ds_read_b64_tr_b16 v[72:73], v18 offset:6144
    ds_read_b64_tr_b16 v[74:75], v18 offset:6400
    v_mfma_f32_32x32x16_bf16 v[88:103], a[68:71], v[84:87], v[88:103]
    ds_read_b64_tr_b16 v[76:77], v18 offset:34816
    ds_read_b64_tr_b16 v[78:79], v18 offset:35072
    s_waitcnt lgkmcnt(4)
    v_mfma_f32_32x32x16_bf16 v[88:103], a[72:75], v[64:67], v[88:103]
    ds_read_b64_tr_b16 v[80:81], v19 offset:6144
    ds_read_b64_tr_b16 v[82:83], v19 offset:6400
    v_mfma_f32_32x32x16_bf16 v[88:103], a[76:79], v[68:71], v[88:103]
    ds_read_b64_tr_b16 v[84:85], v19 offset:34816
    ds_read_b64_tr_b16 v[86:87], v19 offset:35072
    s_waitcnt lgkmcnt(4)
    v_mfma_f32_32x32x16_bf16 v[88:103], a[80:83], v[72:75], v[88:103]
    ds_read_b64_tr_b16 v[64:65], v18 offset:7168
    ds_read_b64_tr_b16 v[66:67], v18 offset:7424
    v_mfma_f32_32x32x16_bf16 v[88:103], a[84:87], v[76:79], v[88:103]
    s_add_u32 m0, s80, 20480
    s_bfe_u32 s92, s34, 262144
    s_mul_i32 s92, s92, 114688
    s_add_u32 s92, s92, s38
    s_add_u32 s92, s92, 28672
    buffer_load_dwordx4 v6, s[52:55], s92 offen lds
    buffer_load_dwordx4 v140, s[52:55], s92 offen offset:1024 lds
    ds_read_b64_tr_b16 v[68:69], v18 offset:35840
    ds_read_b64_tr_b16 v[70:71], v18 offset:36096
    s_waitcnt lgkmcnt(4)
    v_mfma_f32_32x32x16_bf16 v[88:103], a[88:91], v[80:83], v[88:103]
    ds_read_b64_tr_b16 v[72:73], v19 offset:7168
    ds_read_b64_tr_b16 v[74:75], v19 offset:7424
    v_mfma_f32_32x32x16_bf16 v[88:103], a[92:95], v[84:87], v[88:103]
    ds_read_b64_tr_b16 v[76:77], v19 offset:35840
    ds_read_b64_tr_b16 v[78:79], v19 offset:36096
    s_waitcnt lgkmcnt(4)
    v_mfma_f32_32x32x16_bf16 v[88:103], a[96:99], v[64:67], v[88:103]
    v_mfma_f32_32x32x16_bf16 v[88:103], a[100:103], v[68:71], v[88:103]
    s_waitcnt lgkmcnt(0)
    v_mfma_f32_32x32x16_bf16 v[88:103], a[104:107], v[72:75], v[88:103]
    v_mfma_f32_32x32x16_bf16 v[88:103], a[108:111], v[76:79], v[88:103]
    s_add_u32 m0, s80, 24576
    s_bfe_u32 s92, s34, 262144
    s_mul_i32 s92, s92, 114688
    s_add_u32 s92, s92, s38
    s_add_u32 s92, s92, 43008
    buffer_load_dwordx4 v6, s[52:55], s92 offen lds
    buffer_load_dwordx4 v140, s[52:55], s92 offen offset:1024 lds
    s_nop 4
    v_cvt_pk_bf16_f32 v104, v88, v89
    v_cvt_pk_bf16_f32 v105, v90, v91
    v_cvt_pk_bf16_f32 v106, v92, v93
    v_cvt_pk_bf16_f32 v107, v94, v95
    v_cvt_pk_bf16_f32 v108, v96, v97
    v_cvt_pk_bf16_f32 v109, v98, v99
    v_cvt_pk_bf16_f32 v110, v100, v101
    v_cvt_pk_bf16_f32 v111, v102, v103
    v_mov_b32 v30, 0x3f803f80
    v_cndmask_b32 v104, v104, v30, s[98:99]
    v_cndmask_b32 v105, v105, v30, s[98:99]
    v_cndmask_b32 v106, v106, v30, s[98:99]
    v_cndmask_b32 v107, v107, v30, s[98:99]
    v_cndmask_b32 v108, v108, v30, s[98:99]
    v_cndmask_b32 v109, v109, v30, s[98:99]
    v_cndmask_b32 v110, v110, v30, s[98:99]
    v_cndmask_b32 v111, v111, v30, s[98:99]
    v_add_u32 v31, s80, v1
    ds_write_b128 v31, v[104:107] offset:8192
    ds_write_b128 v31, v[108:111] offset:9216
    s_waitcnt lgkmcnt(0)
    s_barrier
    ds_read_b64_tr_b16 v[64:65], v18 offset:10240
    ds_read_b64_tr_b16 v[66:67], v18 offset:10496
    ds_read_b64_tr_b16 v[68:69], v18 offset:38912
    ds_read_b64_tr_b16 v[70:71], v18 offset:39168
    ds_read_b64_tr_b16 v[72:73], v19 offset:10240
    ds_read_b64_tr_b16 v[74:75], v19 offset:10496
    ds_read_b64_tr_b16 v[76:77], v19 offset:38912
    ds_read_b64_tr_b16 v[78:79], v19 offset:39168
    s_waitcnt lgkmcnt(4)
    v_mfma_f32_32x32x16_bf16 v[88:103], v[64:67], a[0:3], 0
    ds_read_b64_tr_b16 v[80:81], v18 offset:11264
    ds_read_b64_tr_b16 v[82:83], v18 offset:11520
    v_mfma_f32_32x32x16_bf16 v[88:103], v[68:71], a[4:7], v[88:103]
    ds_read_b64_tr_b16 v[84:85], v18 offset:39936
    ds_read_b64_tr_b16 v[86:87], v18 offset:40192
    s_waitcnt lgkmcnt(4)
    v_mfma_f32_32x32x16_bf16 v[88:103], v[72:75], a[8:11], v[88:103]
    ds_read_b64_tr_b16 v[64:65], v19 offset:11264
    ds_read_b64_tr_b16 v[66:67], v19 offset:11520
    v_mfma_f32_32x32x16_bf16 v[88:103], v[76:79], a[12:15], v[88:103]
    ds_read_b64_tr_b16 v[68:69], v19 offset:39936
    ds_read_b64_tr_b16 v[70:71], v19 offset:40192
    s_waitcnt lgkmcnt(4)
    v_mfma_f32_32x32x16_bf16 v[88:103], v[80:83], a[16:19], v[88:103]
    ds_read_b64_tr_b16 v[72:73], v18 offset:14336
    ds_read_b64_tr_b16 v[74:75], v18 offset:14592
    v_mfma_f32_32x32x16_bf16 v[88:103], v[84:87], a[20:23], v[88:103]
    ds_read_b64_tr_b16 v[76:77], v18 offset:43008
    ds_read_b64_tr_b16 v[78:79], v18 offset:43264
    s_waitcnt lgkmcnt(4)
    v_mfma_f32_32x32x16_bf16 v[88:103], v[64:67], a[24:27], v[88:103]
    ds_read_b64_tr_b16 v[80:81], v19 offset:14336
    ds_read_b64_tr_b16 v[82:83], v19 offset:14592
    v_mfma_f32_32x32x16_bf16 v[88:103], v[68:71], a[28:31], v[88:103]
    ds_read_b64_tr_b16 v[84:85], v19 offset:43008
    ds_read_b64_tr_b16 v[86:87], v19 offset:43264
    s_waitcnt lgkmcnt(4)
    v_mfma_f32_32x32x16_bf16 v[88:103], v[72:75], a[32:35], v[88:103]
    ds_read_b64_tr_b16 v[64:65], v18 offset:15360
    ds_read_b64_tr_b16 v[66:67], v18 offset:15616
    v_mfma_f32_32x32x16_bf16 v[88:103], v[76:79], a[36:39], v[88:103]
    s_add_u32 m0, s35, 2048
    s_bfe_u32 s92, s34, 262148
    s_mul_i32 s92, s92, 114688
    s_add_u32 s92, s92, s38
    s_add_u32 s92, s92, 14336
    buffer_load_dwordx4 v6, s[52:55], s92 offen lds
    buffer_load_dwordx4 v140, s[52:55], s92 offen offset:1024 lds
    ds_read_b64_tr_b16 v[68:69], v18 offset:44032
    ds_read_b64_tr_b16 v[70:71], v18 offset:44288
    s_waitcnt lgkmcnt(4)
    v_mfma_f32_32x32x16_bf16 v[88:103], v[80:83], a[40:43], v[88:103]
    ds_read_b64_tr_b16 v[72:73], v19 offset:15360
    ds_read_b64_tr_b16 v[74:75], v19 offset:15616
    v_mfma_f32_32x32x16_bf16 v[88:103], v[84:87], a[44:47], v[88:103]
    ds_read_b64_tr_b16 v[76:77], v19 offset:44032
    ds_read_b64_tr_b16 v[78:79], v19 offset:44288
    s_waitcnt lgkmcnt(4)
    v_mfma_f32_32x32x16_bf16 v[88:103], v[64:67], a[48:51], v[88:103]
    ds_read_b64_tr_b16 v[80:81], v18 offset:18432
    ds_read_b64_tr_b16 v[82:83], v18 offset:18688
    v_mfma_f32_32x32x16_bf16 v[88:103], v[68:71], a[52:55], v[88:103]
    ds_read_b64_tr_b16 v[84:85], v18 offset:47104
    ds_read_b64_tr_b16 v[86:87], v18 offset:47360
    s_waitcnt lgkmcnt(4)
    v_mfma_f32_32x32x16_bf16 v[88:103], v[72:75], a[56:59], v[88:103]
    ds_read_b64_tr_b16 v[64:65], v19 offset:18432
    ds_read_b64_tr_b16 v[66:67], v19 offset:18688
    v_mfma_f32_32x32x16_bf16 v[88:103], v[76:79], a[60:63], v[88:103]
    ds_read_b64_tr_b16 v[68:69], v19 offset:47104
    ds_read_b64_tr_b16 v[70:71], v19 offset:47360
    s_waitcnt lgkmcnt(4)
    v_mfma_f32_32x32x16_bf16 v[88:103], v[80:83], a[64:67], v[88:103]
    ds_read_b64_tr_b16 v[72:73], v18 offset:19456
    ds_read_b64_tr_b16 v[74:75], v18 offset:19712
    v_mfma_f32_32x32x16_bf16 v[88:103], v[84:87], a[68:71], v[88:103]
    s_add_u32 m0, s35, 6144
    s_bfe_u32 s92, s34, 262148
    s_mul_i32 s92, s92, 114688
    s_add_u32 s92, s92, s38
    s_add_u32 s92, s92, 43008
    buffer_load_dwordx4 v6, s[52:55], s92 offen lds
    buffer_load_dwordx4 v140, s[52:55], s92 offen offset:1024 lds
    ds_read_b64_tr_b16 v[76:77], v18 offset:48128
    ds_read_b64_tr_b16 v[78:79], v18 offset:48384
    s_waitcnt lgkmcnt(4)
    v_mfma_f32_32x32x16_bf16 v[88:103], v[64:67], a[72:75], v[88:103]
    ds_read_b64_tr_b16 v[80:81], v19 offset:19456
    ds_read_b64_tr_b16 v[82:83], v19 offset:19712
    v_mfma_f32_32x32x16_bf16 v[88:103], v[68:71], a[76:79], v[88:103]
    ds_read_b64_tr_b16 v[84:85], v19 offset:48128
    ds_read_b64_tr_b16 v[86:87], v19 offset:48384
    s_waitcnt lgkmcnt(4)
    v_mfma_f32_32x32x16_bf16 v[88:103], v[72:75], a[80:83], v[88:103]
    ds_read_b64_tr_b16 v[64:65], v18 offset:22528
    ds_read_b64_tr_b16 v[66:67], v18 offset:22784
    v_mfma_f32_32x32x16_bf16 v[88:103], v[76:79], a[84:87], v[88:103]
    ds_read_b64_tr_b16 v[68:69], v18 offset:51200
    ds_read_b64_tr_b16 v[70:71], v18 offset:51456
    s_waitcnt lgkmcnt(4)
    v_mfma_f32_32x32x16_bf16 v[88:103], v[80:83], a[88:91], v[88:103]
    ds_read_b64_tr_b16 v[72:73], v19 offset:22528
    ds_read_b64_tr_b16 v[74:75], v19 offset:22784
    v_mfma_f32_32x32x16_bf16 v[88:103], v[84:87], a[92:95], v[88:103]
    ds_read_b64_tr_b16 v[76:77], v19 offset:51200
    ds_read_b64_tr_b16 v[78:79], v19 offset:51456
    s_waitcnt lgkmcnt(4)
    v_mfma_f32_32x32x16_bf16 v[88:103], v[64:67], a[96:99], v[88:103]
    v_mfma_f32_32x32x16_bf16 v[88:103], v[68:71], a[100:103], v[88:103]
    s_add_u32 m0, s35, 10240
    s_bfe_u32 s92, s34, 262152
    s_mul_i32 s92, s92, 114688
    s_add_u32 s92, s92, s38
    s_add_u32 s92, s92, 14336
    buffer_load_dwordx4 v6, s[52:55], s92 offen lds
    buffer_load_dwordx4 v140, s[52:55], s92 offen offset:1024 lds
    s_waitcnt lgkmcnt(0)
    v_mfma_f32_32x32x16_bf16 v[88:103], v[72:75], a[104:107], v[88:103]
    v_mfma_f32_32x32x16_bf16 v[88:103], v[76:79], a[108:111], v[88:103]
    s_add_u32 s88, s65, 1835008
    buffer_load_dword v137, v26, s[40:43], s88 offen sc1
    s_nop 9
    v_mov_b32 v28, v100
    v_mov_b32 v30, v100
    s_nop 1
    v_permlane32_swap_b32 v30, v28
    v_mul_f32 v28, s27, v28
    v_exp_f32 v28, v28
    v_and_b32 v30, 31, v0
    v_lshlrev_b32 v30, 2, v30
    v_add_f32 v28, 1.0, v28
    v_rcp_f32 v28, v28
    s_lshl_b32 s87, s78, 7
    s_add_u32 s87, s87, 55296
    v_add_u32 v30, s87, v30
    ds_write_b32 v30, v28
    ds_read_b64_tr_b16 v[128:129], v139 offset:0
    ds_read_b64_tr_b16 v[130:131], v139 offset:448
    ds_read_b64_tr_b16 v[132:133], v139 offset:896
    ds_read_b64_tr_b16 v[134:135], v139 offset:1344
    s_waitcnt lgkmcnt(0)
    v_cvt_pk_bf16_f32 v80, v88, v89
    v_cvt_pk_bf16_f32 v81, v90, v91
    v_cvt_pk_bf16_f32 v82, v92, v93
    v_cvt_pk_bf16_f32 v83, v94, v95
    v_cvt_pk_bf16_f32 v84, v96, v97
    v_cvt_pk_bf16_f32 v85, v98, v99
    v_cvt_pk_bf16_f32 v86, v100, v101
    v_cvt_pk_bf16_f32 v87, v102, v103
    v_mfma_f32_32x32x16_bf16 v[104:119], v[128:131], v[80:83], 0
    s_nop 0
    v_mfma_f32_32x32x16_bf16 v[104:119], v[132:135], v[84:87], v[104:119]
    s_waitcnt vmcnt(0)
    v_cmp_ne_u32 vcc, v27, v137
    s_cbranch_vccz POLLD_19
    s_add_u32 s88, s65, 1835008
    s_mov_b32 s91, 0x40000
POLL_18:
    buffer_load_dword v137, v26, s[40:43], s88 offen sc1
    s_waitcnt vmcnt(0)
    v_cmp_ne_u32 vcc, v27, v137
    s_cbranch_vccz POLLD_19
    s_sub_u32 s91, s91, 1
    s_cmp_eq_u32 s91, 0
    s_cbranch_scc1 POLLD_19
    s_sleep 1
    s_branch POLL_18
POLLD_19:
    s_bfe_u32 s32, s34, 262144
    s_lshl_b32 s32, s32, 13
    s_add_u32 s32, s32, s68
    buffer_load_dwordx4 a[0:3], v1, s[48:51], s32 offen offset:0 sc1
    buffer_load_dwordx4 a[4:7], v1, s[48:51], s32 offen offset:1024 sc1
    buffer_load_dwordx4 a[8:11], v1, s[48:51], s32 offen offset:2048 sc1
    buffer_load_dwordx4 a[12:15], v1, s[48:51], s32 offen offset:3072 sc1
    s_waitcnt lgkmcnt(0)
    s_barrier
    v_cndmask_b32 v7, v116, v104, s[96:97]
    s_bfe_u32 s32, s34, 262148
    s_lshl_b32 s32, s32, 13
    s_add_u32 s32, s32, s68
    buffer_load_dwordx4 a[16:19], v1, s[48:51], s32 offen offset:0 sc1
    v_cndmask_b32 v8, v117, v104, s[96:97]
    v_cndmask_b32 v9, v118, v104, s[96:97]
    v_cndmask_b32 v10, v119, v104, s[96:97]
    v_max3_f32 v11, v104, v105, v106
    v_min3_f32 v12, v104, v105, v106
    v_max3_f32 v11, v11, v107, v108
    v_min3_f32 v12, v12, v107, v108
    v_max3_f32 v11, v11, v109, v110
    v_min3_f32 v12, v12, v109, v110
    v_max3_f32 v11, v11, v111, v112
    v_min3_f32 v12, v12, v111, v112
    v_max3_f32 v11, v11, v113, v114
    v_min3_f32 v12, v12, v113, v114
    v_max3_f32 v11, v11, v115, v7
    v_min3_f32 v12, v12, v115, v7
    v_max3_f32 v11, v11, v8, v9
    v_min3_f32 v12, v12, v8, v9
    v_max_f32 v11, v11, v10
    v_min_f32 v12, v12, v10
    v_mov_b32 v13, v11
    v_mov_b32 v14, v12
    s_nop 0
    v_permlane32_swap_b32 v11, v13
    v_permlane32_swap_b32 v12, v14
    v_max_f32 v11, v11, v13
    v_min_f32 v12, v12, v14
    v_mul_f32 v7, s27, v11
    v_mul_f32 v8, s90, v12
    v_mov_b32 v13, 0xff800000
    v_cndmask_b32 v10, v8, v13, s[96:97]
    v_cndmask_b32 v9, v7, v13, s[96:97]
    v_fma_f32 v120, v104, s90, v7
    v_fma_f32 v121, v105, s90, v7
    v_fma_f32 v122, v106, s90, v7
    v_fma_f32 v123, v107, s90, v7
    v_exp_f32 v120, v120
    v_exp_f32 v121, v121
    v_exp_f32 v122, v122
    v_exp_f32 v123, v123
    v_fma_f32 v124, v108, s90, v7
    v_fma_f32 v125, v109, s90, v7
    v_fma_f32 v126, v110, s90, v7
    v_fma_f32 v127, v111, s90, v7
    v_exp_f32 v124, v124
    v_exp_f32 v125, v125
    v_exp_f32 v126, v126
    v_exp_f32 v127, v127
    v_fma_f32 v128, v112, s90, v7
    v_fma_f32 v129, v113, s90, v7
    v_fma_f32 v130, v114, s90, v7
    v_fma_f32 v131, v115, s90, v7
    v_exp_f32 v128, v128
    v_exp_f32 v129, v129
    buffer_load_dwordx4 a[20:23], v1, s[48:51], s32 offen offset:1024 sc1
    v_exp_f32 v130, v130
    v_exp_f32 v131, v131
    v_fma_f32 v132, v116, s90, v9
    v_fma_f32 v133, v117, s90, v9
    v_fma_f32 v134, v118, s90, v9
    v_fma_f32 v135, v119, s90, v9
    v_exp_f32 v132, v132
    v_exp_f32 v133, v133
    v_exp_f32 v134, v134
    buffer_load_dwordx4 a[24:27], v1, s[48:51], s32 offen offset:2048 sc1
    v_exp_f32 v135, v135
    v_add_f32 v11, v120, v121
    v_add_f32 v14, v122, v123
    v_add_f32 v11, v11, v124
    v_add_f32 v14, v14, v125
    v_add_f32 v11, v11, v126
    v_add_f32 v14, v14, v127
    v_add_f32 v11, v11, v128
    v_add_f32 v14, v14, v129
    v_add_f32 v11, v11, v130
    v_add_f32 v14, v14, v131
    v_add_f32 v11, v11, v132
    v_add_f32 v14, v14, v133
    v_add_f32 v11, v11, v134
    v_add_f32 v14, v14, v135
    buffer_load_dwordx4 a[28:31], v1, s[48:51], s32 offen offset:3072 sc1
    v_add_f32 v11, v11, v14
    v_mov_b32 v14, v11
    s_nop 1
    v_permlane32_swap_b32 v11, v14
    v_add_f32 v11, v11, v14
    v_rcp_f32 v11, v11
    s_nop 0
    v_mul_f32 v120, v120, v11
    v_mul_f32 v121, v121, v11
    v_cvt_pk_bf16_f32 v64, v120, v121
    v_mul_f32 v122, v122, v11
    v_mul_f32 v123, v123, v11
    v_cvt_pk_bf16_f32 v65, v122, v123
    v_mul_f32 v124, v124, v11
    v_mul_f32 v125, v125, v11
    v_cvt_pk_bf16_f32 v66, v124, v125
    s_bfe_u32 s32, s34, 262152
    s_lshl_b32 s32, s32, 13
    s_add_u32 s32, s32, s68
    buffer_load_dwordx4 a[32:35], v1, s[48:51], s32 offen offset:0 sc1
    v_mul_f32 v126, v126, v11
    v_mul_f32 v127, v127, v11
    v_cvt_pk_bf16_f32 v67, v126, v127
    v_mul_f32 v128, v128, v11
    v_mul_f32 v129, v129, v11
    v_cvt_pk_bf16_f32 v68, v128, v129
    v_mul_f32 v130, v130, v11
    v_mul_f32 v131, v131, v11
    v_cvt_pk_bf16_f32 v69, v130, v131
    v_mul_f32 v132, v132, v11
    v_mul_f32 v133, v133, v11
    v_cvt_pk_bf16_f32 v70, v132, v133
    v_mul_f32 v134, v134, v11
    v_mul_f32 v135, v135, v11
    v_cvt_pk_bf16_f32 v71, v134, v135
    v_fma_f32 v120, v104, s27, v8
    v_fma_f32 v121, v105, s27, v8
    v_fma_f32 v122, v106, s27, v8
    v_fma_f32 v123, v107, s27, v8
    v_exp_f32 v120, v120
    v_exp_f32 v121, v121
    v_exp_f32 v122, v122
    v_exp_f32 v123, v123
    v_fma_f32 v124, v108, s27, v8
    v_fma_f32 v125, v109, s27, v8
    v_fma_f32 v126, v110, s27, v8
    v_fma_f32 v127, v111, s27, v8
    v_exp_f32 v124, v124
    v_exp_f32 v125, v125
    v_exp_f32 v126, v126
    v_exp_f32 v127, v127
    v_fma_f32 v128, v112, s27, v8
    v_fma_f32 v129, v113, s27, v8
    v_fma_f32 v130, v114, s27, v8
    v_fma_f32 v131, v115, s27, v8
    v_exp_f32 v128, v128
    v_exp_f32 v129, v129
    v_exp_f32 v130, v130
    v_exp_f32 v131, v131
    v_fma_f32 v132, v116, s27, v10
    v_fma_f32 v133, v117, s27, v10
    v_fma_f32 v134, v118, s27, v10
    v_fma_f32 v135, v119, s27, v10
    v_exp_f32 v132, v132
    v_exp_f32 v133, v133
    v_exp_f32 v134, v134
    buffer_load_dwordx4 a[36:39], v1, s[48:51], s32 offen offset:1024 sc1
    v_exp_f32 v135, v135
    v_add_f32 v11, v120, v121
    v_add_f32 v14, v122, v123
    v_add_f32 v11, v11, v124
    v_add_f32 v14, v14, v125
    v_add_f32 v11, v11, v126
    v_add_f32 v14, v14, v127
    v_add_f32 v11, v11, v128
    v_add_f32 v14, v14, v129
    v_add_f32 v11, v11, v130
    v_add_f32 v14, v14, v131
    v_add_f32 v11, v11, v132
    v_add_f32 v14, v14, v133
    v_add_f32 v11, v11, v134
    v_add_f32 v14, v14, v135
    buffer_load_dwordx4 a[40:43], v1, s[48:51], s32 offen offset:2048 sc1
    v_add_f32 v11, v11, v14
    v_mov_b32 v14, v11
    s_nop 1
    v_permlane32_swap_b32 v11, v14
    v_add_f32 v11, v11, v14
    v_rcp_f32 v11, v11
    s_nop 0
    v_mul_f32 v120, v120, v11
    v_mul_f32 v121, v121, v11
    v_cvt_pk_bf16_f32 v72, v120, v121
    v_mul_f32 v122, v122, v11
    v_mul_f32 v123, v123, v11
    v_cvt_pk_bf16_f32 v73, v122, v123
    v_mul_f32 v124, v124, v11
    v_mul_f32 v125, v125, v11
    v_cvt_pk_bf16_f32 v74, v124, v125
    buffer_load_dwordx4 a[44:47], v1, s[48:51], s32 offen offset:3072 sc1
    v_mul_f32 v126, v126, v11
    v_mul_f32 v127, v127, v11
    v_cvt_pk_bf16_f32 v75, v126, v127
    v_mul_f32 v128, v128, v11
    v_mul_f32 v129, v129, v11
    v_cvt_pk_bf16_f32 v76, v128, v129
    v_mul_f32 v130, v130, v11
    v_mul_f32 v131, v131, v11
    v_cvt_pk_bf16_f32 v77, v130, v131
    v_mul_f32 v132, v132, v11
    v_mul_f32 v133, v133, v11
    v_cvt_pk_bf16_f32 v78, v132, v133
    v_mul_f32 v134, v134, v11
    v_mul_f32 v135, v135, v11
    v_cvt_pk_bf16_f32 v79, v134, v135
    s_waitcnt lgkmcnt(0)
    s_barrier
    s_lshr_b32 s87, s73, 3
    s_lshl1_add_u32 s87, s87, s79
    s_lshl_b32 s87, s87, 7
    s_add_u32 s87, s87, 55296
    v_and_b32 v30, 31, v0
    v_lshlrev_b32 v30, 2, v30
    v_add_u32 v30, s87, v30
    ds_read_b32 v138, v30
    s_add_u32 m0, s80, 10240
    s_bfe_u32 s92, s34, 262152
    s_mul_i32 s92, s92, 114688
    s_add_u32 s92, s92, s38
    s_add_u32 s92, s92, 43008
    buffer_load_dwordx4 v6, s[52:55], s92 offen lds
    buffer_load_dwordx4 v140, s[52:55], s92 offen offset:1024 lds
    s_add_u32 m0, s80, 18432
    s_bfe_u32 s92, s33, 262144
    s_mul_i32 s92, s92, s37
    s_add_u32 s92, s92, s36
    s_add_u32 s92, s92, 14336
    buffer_load_dwordx4 v6, s[52:55], s92 offen lds
    buffer_load_dwordx4 v140, s[52:55], s92 offen offset:1024 lds
    s_add_u32 m0, s80, 0
    s_bfe_u32 s92, s33, 262144
    s_mul_i32 s92, s92, s37
    s_add_u32 s92, s92, s36
    s_add_u32 s92, s92, 43008
    buffer_load_dwordx4 v6, s[52:55], s92 offen lds
    buffer_load_dwordx4 v140, s[52:55], s92 offen offset:1024 lds
    s_add_u32 m0, s80, 4096
    s_bfe_u32 s92, s33, 262148
    s_mul_i32 s92, s92, s37
    s_add_u32 s92, s92, s36
    s_add_u32 s92, s92, 14336
    buffer_load_dwordx4 v6, s[52:55], s92 offen lds
    buffer_load_dwordx4 v140, s[52:55], s92 offen offset:1024 lds
    s_waitcnt lgkmcnt(0)
    s_barrier
    ds_read_b64_tr_b16 v[80:81], v22 offset:12288
    ds_read_b64_tr_b16 v[82:83], v22 offset:13312
    ds_read_b64_tr_b16 v[84:85], v23 offset:12288
    ds_read_b64_tr_b16 v[86:87], v23 offset:13312
    v_sub_f32 v138, 1.0, v138
    s_barrier
    ds_read_b64_tr_b16 v[88:89], v22 offset:16384
    ds_read_b64_tr_b16 v[90:91], v22 offset:17408
    ds_read_b64_tr_b16 v[92:93], v23 offset:16384
    ds_read_b64_tr_b16 v[94:95], v23 offset:17408
    s_waitcnt vmcnt(19) lgkmcnt(4)
    v_mfma_f32_32x32x16_bf16 v[32:47], v[80:83], a[0:3], 0
    v_mfma_f32_32x32x16_bf16 v[48:63], v[84:87], a[0:3], 0
    ds_read_b64_tr_b16 v[96:97], v22 offset:20480
    ds_read_b64_tr_b16 v[98:99], v22 offset:21504
    ds_read_b64_tr_b16 v[100:101], v23 offset:20480
    ds_read_b64_tr_b16 v[102:103], v23 offset:21504
    s_waitcnt vmcnt(18) lgkmcnt(4)
    v_mfma_f32_32x32x16_bf16 v[32:47], v[88:91], a[4:7], v[32:47]
    v_mfma_f32_32x32x16_bf16 v[48:63], v[92:95], a[4:7], v[48:63]
    s_barrier
    ds_read_b64_tr_b16 v[80:81], v22 offset:24576
    ds_read_b64_tr_b16 v[82:83], v22 offset:25600
    ds_read_b64_tr_b16 v[84:85], v23 offset:24576
    ds_read_b64_tr_b16 v[86:87], v23 offset:25600
    s_waitcnt vmcnt(17) lgkmcnt(4)
    v_mfma_f32_32x32x16_bf16 v[32:47], v[96:99], a[8:11], v[32:47]
    s_add_u32 s88, s65, 1703936
    buffer_load_dword v137, v26, s[40:43], s88 offen sc1
    v_mfma_f32_32x32x16_bf16 v[48:63], v[100:103], a[8:11], v[48:63]
    s_add_u32 m0, s80, 12288
    s_bfe_u32 s92, s33, 262148
    s_mul_i32 s92, s92, s37
    s_add_u32 s92, s92, s36
    s_add_u32 s92, s92, 43008
    buffer_load_dwordx4 v6, s[52:55], s92 offen lds
    buffer_load_dwordx4 v140, s[52:55], s92 offen offset:1024 lds
    ds_read_b64_tr_b16 v[88:89], v20 offset:0
    ds_read_b64_tr_b16 v[90:91], v20 offset:1024
    ds_read_b64_tr_b16 v[92:93], v21 offset:0
    ds_read_b64_tr_b16 v[94:95], v21 offset:1024
    s_waitcnt vmcnt(19) lgkmcnt(4)
    v_mfma_f32_32x32x16_bf16 v[32:47], v[80:83], a[12:15], v[32:47]
    v_mfma_f32_32x32x16_bf16 v[48:63], v[84:87], a[12:15], v[48:63]
    s_barrier
    ds_read_b64_tr_b16 v[96:97], v20 offset:2048
    ds_read_b64_tr_b16 v[98:99], v20 offset:3072
    ds_read_b64_tr_b16 v[100:101], v21 offset:2048
    ds_read_b64_tr_b16 v[102:103], v21 offset:3072
    s_waitcnt vmcnt(18) lgkmcnt(4)
    v_mfma_f32_32x32x16_bf16 v[32:47], v[88:91], a[16:19], v[32:47]
    s_add_u32 m0, s80, 20480
    s_bfe_u32 s92, s33, 262152
    s_mul_i32 s92, s92, s37
    s_add_u32 s92, s92, s36
    s_add_u32 s92, s92, 14336
    buffer_load_dwordx4 v6, s[52:55], s92 offen lds
    buffer_load_dwordx4 v140, s[52:55], s92 offen offset:1024 lds
    v_mfma_f32_32x32x16_bf16 v[48:63], v[92:95], a[16:19], v[48:63]
    s_waitcnt vmcnt(4)
    v_cmp_ne_u32 vcc, v27, v137
    s_cbranch_vccz POLLD_21
    s_add_u32 s88, s65, 1703936
    s_mov_b32 s91, 0x40000
POLL_20:
    buffer_load_dword v137, v26, s[40:43], s88 offen sc1
    s_waitcnt vmcnt(0)
    v_cmp_ne_u32 vcc, v27, v137
    s_cbranch_vccz POLLD_21
    s_sub_u32 s91, s91, 1
    s_cmp_eq_u32 s91, 0
    s_cbranch_scc1 POLLD_21
    s_sleep 1
    s_branch POLL_20
POLLD_21:
    s_bfe_u32 s32, s33, 262144
    s_mul_i32 s32, s32, s67
    s_add_u32 s32, s32, s39
    buffer_load_dwordx4 a[48:51], v1, s[48:51], s32 offen offset:0 sc1
    buffer_load_dwordx4 a[52:55], v1, s[48:51], s32 offen offset:1024 sc1
    buffer_load_dwordx4 a[56:59], v1, s[48:51], s32 offen offset:2048 sc1
    buffer_load_dwordx4 a[60:63], v1, s[48:51], s32 offen offset:3072 sc1
    s_bfe_u32 s32, s33, 262148
    s_mul_i32 s32, s32, s67
    s_add_u32 s32, s32, s39
    buffer_load_dwordx4 a[64:67], v1, s[48:51], s32 offen offset:0 sc1
    ds_read_b64_tr_b16 v[80:81], v20 offset:4096
    ds_read_b64_tr_b16 v[82:83], v20 offset:5120
    ds_read_b64_tr_b16 v[84:85], v21 offset:4096
    ds_read_b64_tr_b16 v[86:87], v21 offset:5120
    s_waitcnt lgkmcnt(4)
    v_mfma_f32_32x32x16_bf16 v[32:47], v[96:99], a[20:23], v[32:47]
    v_mfma_f32_32x32x16_bf16 v[48:63], v[100:103], a[20:23], v[48:63]
    buffer_load_dwordx4 a[68:71], v1, s[48:51], s32 offen offset:1024 sc1
    s_barrier
    ds_read_b64_tr_b16 v[88:89], v20 offset:6144
    ds_read_b64_tr_b16 v[90:91], v20 offset:7168
    ds_read_b64_tr_b16 v[92:93], v21 offset:6144
    ds_read_b64_tr_b16 v[94:95], v21 offset:7168
    s_waitcnt lgkmcnt(4)
    v_mfma_f32_32x32x16_bf16 v[32:47], v[80:83], a[24:27], v[32:47]
    v_mfma_f32_32x32x16_bf16 v[48:63], v[84:87], a[24:27], v[48:63]
    s_add_u32 m0, s35, 0
    s_bfe_u32 s92, s33, 262152
    s_mul_i32 s92, s92, s37
    s_add_u32 s92, s92, s36
    s_add_u32 s92, s92, 43008
    buffer_load_dwordx4 v6, s[52:55], s92 offen lds
    buffer_load_dwordx4 v140, s[52:55], s92 offen offset:1024 lds
    buffer_load_dwordx4 a[72:75], v1, s[48:51], s32 offen offset:2048 sc1
    ds_read_b64_tr_b16 v[96:97], v20 offset:8192
    ds_read_b64_tr_b16 v[98:99], v20 offset:9216
    ds_read_b64_tr_b16 v[100:101], v21 offset:8192
    ds_read_b64_tr_b16 v[102:103], v21 offset:9216
    s_waitcnt lgkmcnt(4)
    v_mfma_f32_32x32x16_bf16 v[32:47], v[88:91], a[28:31], v[32:47]
    v_mfma_f32_32x32x16_bf16 v[48:63], v[92:95], a[28:31], v[48:63]
    buffer_load_dwordx4 a[76:79], v1, s[48:51], s32 offen offset:3072 sc1
    s_barrier
    ds_read_b64_tr_b16 v[80:81], v20 offset:10240
    ds_read_b64_tr_b16 v[82:83], v20 offset:11264
    ds_read_b64_tr_b16 v[84:85], v21 offset:10240
    ds_read_b64_tr_b16 v[86:87], v21 offset:11264
    s_waitcnt lgkmcnt(4)
    v_mfma_f32_32x32x16_bf16 v[32:47], v[96:99], a[32:35], v[32:47]
    v_mfma_f32_32x32x16_bf16 v[48:63], v[100:103], a[32:35], v[48:63]
    s_add_u32 m0, s35, 4096
    s_bfe_u32 s92, s33, 262156
    s_mul_i32 s92, s92, s37
    s_add_u32 s92, s92, s36
    s_add_u32 s92, s92, 14336
    buffer_load_dwordx4 v6, s[52:55], s92 offen lds
    buffer_load_dwordx4 v140, s[52:55], s92 offen offset:1024 lds
    s_bfe_u32 s32, s33, 262152
    s_mul_i32 s32, s32, s67
    s_add_u32 s32, s32, s39
    buffer_load_dwordx4 a[80:83], v1, s[48:51], s32 offen offset:0 sc1
    ds_read_b64_tr_b16 v[88:89], v22 offset:6144
    ds_read_b64_tr_b16 v[90:91], v22 offset:7168
    ds_read_b64_tr_b16 v[92:93], v23 offset:6144
    ds_read_b64_tr_b16 v[94:95], v23 offset:7168
    s_waitcnt lgkmcnt(4)
    v_mfma_f32_32x32x16_bf16 v[32:47], v[80:83], a[36:39], v[32:47]
    v_mfma_f32_32x32x16_bf16 v[48:63], v[84:87], a[36:39], v[48:63]
    buffer_load_dwordx4 a[84:87], v1, s[48:51], s32 offen offset:1024 sc1
    s_barrier
    ds_read_b64_tr_b16 v[96:97], v22 offset:10240
    ds_read_b64_tr_b16 v[98:99], v22 offset:11264
    ds_read_b64_tr_b16 v[100:101], v23 offset:10240
    ds_read_b64_tr_b16 v[102:103], v23 offset:11264
    s_waitcnt lgkmcnt(4)
    v_mfma_f32_32x32x16_bf16 v[32:47], v[88:91], a[40:43], v[32:47]
    s_add_u32 m0, s35, 8192
    s_bfe_u32 s92, s33, 262156
    s_mul_i32 s92, s92, s37
    s_add_u32 s92, s92, s36
    s_add_u32 s92, s92, 43008
    buffer_load_dwordx4 v6, s[52:55], s92 offen lds
    buffer_load_dwordx4 v140, s[52:55], s92 offen offset:1024 lds
    buffer_load_dwordx4 a[88:91], v1, s[48:51], s32 offen offset:2048 sc1
    v_mfma_f32_32x32x16_bf16 v[48:63], v[92:95], a[40:43], v[48:63]
    v_add_u32 v136, 57344, v1
    ds_read_b128 v[120:123], v1 offset:27648
    ds_read_b128 v[124:127], v1 offset:56320
    ds_read_b128 v[128:131], v136 offset:27648
    ds_read_b128 v[132:135], v136 offset:56320
    s_waitcnt lgkmcnt(3)
    v_mfma_f32_32x32x16_bf16 v[104:119], v[120:123], v[64:67], 0
    s_waitcnt lgkmcnt(2)
    v_mfma_f32_32x32x16_bf16 v[104:119], v[124:127], v[68:71], v[104:119]
    s_waitcnt lgkmcnt(1)
    v_mfma_f32_32x32x16_bf16 v[104:119], v[128:131], v[72:75], v[104:119]
    s_waitcnt lgkmcnt(0)
    v_mfma_f32_32x32x16_bf16 v[104:119], v[132:135], v[76:79], v[104:119]
    ds_read_b64_tr_b16 v[80:81], v22 offset:14336
    ds_read_b64_tr_b16 v[82:83], v22 offset:15360
    ds_read_b64_tr_b16 v[84:85], v23 offset:14336
    ds_read_b64_tr_b16 v[86:87], v23 offset:15360
    v_mfma_f32_32x32x16_bf16 v[32:47], v[96:99], a[44:47], v[32:47]
    buffer_load_dwordx4 a[92:95], v1, s[48:51], s32 offen offset:3072 sc1
    s_nop 5
    v_mov_b32 v30, v116
    v_mov_b32 v136, v116
    s_nop 1
    v_permlane32_swap_b32 v136, v30
    v_add_f32 v30, 0x358637bd, v30
    v_rcp_f32 v30, v30
    v_mov_b32 v136, 0
    v_mul_f32 v30, v30, v28
    v_cndmask_b32 v31, v30, v136, s[96:97]
    v_mul_f32 v104, v104, v30
    v_mul_f32 v105, v105, v30
    v_mul_f32 v106, v106, v30
    v_mul_f32 v107, v107, v30
    v_mul_f32 v108, v108, v30
    v_mul_f32 v109, v109, v30
    v_mul_f32 v110, v110, v30
    v_mul_f32 v111, v111, v30
    v_mul_f32 v112, v112, v30
    v_mul_f32 v113, v113, v30
    v_mul_f32 v114, v114, v30
    v_mul_f32 v115, v115, v30
    v_mul_f32 v116, v116, v31
    v_mul_f32 v117, v117, v31
    v_mfma_f32_32x32x16_bf16 v[48:63], v[100:103], a[44:47], v[48:63]
    v_mul_f32 v118, v118, v31
    v_mul_f32 v119, v119, v31
    v_cvt_pk_bf16_f32 v120, v104, v105
    v_cvt_pk_bf16_f32 v121, v106, v107
    v_cvt_pk_bf16_f32 v122, v108, v109
    v_cvt_pk_bf16_f32 v123, v110, v111
    v_cvt_pk_bf16_f32 v124, v112, v113
    v_cvt_pk_bf16_f32 v125, v114, v115
    v_cvt_pk_bf16_f32 v126, v116, v117
    v_cvt_pk_bf16_f32 v127, v118, v119
    v_mov_b32 v30, -2
    v_min_u32 v120, v120, v30
    v_min_u32 v121, v121, v30
    v_min_u32 v122, v122, v30
    v_min_u32 v123, v123, v30
    v_min_u32 v124, v124, v30
    v_min_u32 v125, v125, v30
    v_min_u32 v126, v126, v30
    v_min_u32 v127, v127, v30
    s_lshl_b32 s87, s73, 11
    s_add_u32 s87, s87, s85
    s_add_u32 s87, s87, 114688
    buffer_store_dwordx4 v[120:123], v1, s[40:43], s87 offen offset:0 sc1
    buffer_store_dwordx4 v[124:127], v1, s[40:43], s87 offen offset:1024 sc1
    s_barrier
    ds_read_b64_tr_b16 v[88:89], v22 offset:18432
    ds_read_b64_tr_b16 v[90:91], v22 offset:19456
    ds_read_b64_tr_b16 v[92:93], v23 offset:18432
    ds_read_b64_tr_b16 v[94:95], v23 offset:19456
    s_waitcnt vmcnt(19) lgkmcnt(4)
    v_mfma_f32_32x32x16_bf16 v[32:47], v[80:83], a[48:51], v[32:47]
    v_mfma_f32_32x32x16_bf16 v[48:63], v[84:87], a[48:51], v[48:63]
    s_add_u32 m0, s80, 6144
    s_bfe_u32 s92, s33, 262144
    s_mul_i32 s92, s92, 25088
    s_add_u32 s92, s92, s30
    s_add_u32 s92, s92, 14336
    buffer_load_dwordx4 v6, s[56:59], s92 offen lds
    buffer_load_dwordx4 v140, s[56:59], s92 offen offset:1024 lds
    s_bfe_u32 s32, s33, 262156
    s_mul_i32 s32, s32, s67
    s_add_u32 s32, s32, s39
    buffer_load_dwordx4 a[96:99], v1, s[48:51], s32 offen offset:0 sc1
    ds_read_b64_tr_b16 v[96:97], v22 offset:22528
    ds_read_b64_tr_b16 v[98:99], v22 offset:23552
    ds_read_b64_tr_b16 v[100:101], v23 offset:22528
    ds_read_b64_tr_b16 v[102:103], v23 offset:23552
    s_waitcnt vmcnt(21) lgkmcnt(4)
    v_mfma_f32_32x32x16_bf16 v[32:47], v[88:91], a[52:55], v[32:47]
    v_mfma_f32_32x32x16_bf16 v[48:63], v[92:95], a[52:55], v[48:63]
    buffer_load_dwordx4 a[100:103], v1, s[48:51], s32 offen offset:1024 sc1
    s_barrier
    ds_read_b64_tr_b16 v[80:81], v22 offset:0
    ds_read_b64_tr_b16 v[82:83], v22 offset:1024
    ds_read_b64_tr_b16 v[84:85], v23 offset:0
    ds_read_b64_tr_b16 v[86:87], v23 offset:1024
    s_waitcnt vmcnt(21) lgkmcnt(4)
    v_mfma_f32_32x32x16_bf16 v[32:47], v[96:99], a[56:59], v[32:47]
    v_mfma_f32_32x32x16_bf16 v[48:63], v[100:103], a[56:59], v[48:63]
    s_add_u32 m0, s80, 14336
    s_bfe_u32 s92, s33, 262148
    s_mul_i32 s92, s92, 25088
    s_add_u32 s92, s92, s30
    s_add_u32 s92, s92, 14336
    buffer_load_dwordx4 v6, s[56:59], s92 offen lds
    buffer_load_dwordx4 v140, s[56:59], s92 offen offset:1024 lds
    buffer_load_dwordx4 a[104:107], v1, s[48:51], s32 offen offset:2048 sc1
    ds_read_b64_tr_b16 v[88:89], v22 offset:2048
    ds_read_b64_tr_b16 v[90:91], v22 offset:3072
    ds_read_b64_tr_b16 v[92:93], v23 offset:2048
    ds_read_b64_tr_b16 v[94:95], v23 offset:3072
    s_waitcnt vmcnt(23) lgkmcnt(4)
    v_mfma_f32_32x32x16_bf16 v[32:47], v[80:83], a[60:63], v[32:47]
    v_mfma_f32_32x32x16_bf16 v[48:63], v[84:87], a[60:63], v[48:63]
    buffer_load_dwordx4 a[108:111], v1, s[48:51], s32 offen offset:3072 sc1
    s_barrier
    ds_read_b64_tr_b16 v[96:97], v22 offset:4096
    ds_read_b64_tr_b16 v[98:99], v22 offset:5120
    ds_read_b64_tr_b16 v[100:101], v23 offset:4096
    ds_read_b64_tr_b16 v[102:103], v23 offset:5120
    s_waitcnt vmcnt(23) lgkmcnt(4)
    v_mfma_f32_32x32x16_bf16 v[32:47], v[88:91], a[64:67], v[32:47]
    v_mfma_f32_32x32x16_bf16 v[48:63], v[92:95], a[64:67], v[48:63]
    s_add_u32 m0, s80, 22528
    s_bfe_u32 s92, s33, 262152
    s_mul_i32 s92, s92, 25088
    s_add_u32 s92, s92, s30
    s_add_u32 s92, s92, 14336
    buffer_load_dwordx4 v6, s[56:59], s92 offen lds
    buffer_load_dwordx4 v140, s[56:59], s92 offen offset:1024 lds
    ds_read_b64_tr_b16 v[80:81], v22 offset:8192
    ds_read_b64_tr_b16 v[82:83], v22 offset:9216
    ds_read_b64_tr_b16 v[84:85], v23 offset:8192
    ds_read_b64_tr_b16 v[86:87], v23 offset:9216
    s_waitcnt vmcnt(24) lgkmcnt(4)
    v_mfma_f32_32x32x16_bf16 v[32:47], v[96:99], a[68:71], v[32:47]
    v_mfma_f32_32x32x16_bf16 v[48:63], v[100:103], a[68:71], v[48:63]
    s_barrier
    ds_read_b64_tr_b16 v[88:89], v22 offset:12288
    ds_read_b64_tr_b16 v[90:91], v22 offset:13312
    ds_read_b64_tr_b16 v[92:93], v23 offset:12288
    ds_read_b64_tr_b16 v[94:95], v23 offset:13312
    s_waitcnt vmcnt(21) lgkmcnt(4)
    v_mfma_f32_32x32x16_bf16 v[32:47], v[80:83], a[72:75], v[32:47]
    v_mfma_f32_32x32x16_bf16 v[48:63], v[84:87], a[72:75], v[48:63]
    s_add_u32 m0, s80, 2048
    s_bfe_u32 s92, s33, 262156
    s_mul_i32 s92, s92, 25088
    s_add_u32 s92, s92, s30
    s_add_u32 s92, s92, 14336
    buffer_load_dwordx4 v6, s[56:59], s92 offen lds
    buffer_load_dwordx4 v140, s[56:59], s92 offen offset:1024 lds
    ds_read_b64_tr_b16 v[96:97], v22 offset:16384
    ds_read_b64_tr_b16 v[98:99], v22 offset:17408
    ds_read_b64_tr_b16 v[100:101], v23 offset:16384
    ds_read_b64_tr_b16 v[102:103], v23 offset:17408
    s_waitcnt vmcnt(22) lgkmcnt(4)
    v_mfma_f32_32x32x16_bf16 v[32:47], v[88:91], a[76:79], v[32:47]
    v_mfma_f32_32x32x16_bf16 v[48:63], v[92:95], a[76:79], v[48:63]
    s_barrier
    ds_read_b64_tr_b16 v[80:81], v22 offset:20480
    ds_read_b64_tr_b16 v[82:83], v22 offset:21504
    ds_read_b64_tr_b16 v[84:85], v23 offset:20480
    ds_read_b64_tr_b16 v[86:87], v23 offset:21504
    s_waitcnt vmcnt(19) lgkmcnt(4)
    v_mfma_f32_32x32x16_bf16 v[32:47], v[96:99], a[80:83], v[32:47]
    v_mfma_f32_32x32x16_bf16 v[48:63], v[100:103], a[80:83], v[48:63]
    ds_read_b64_tr_b16 v[88:89], v22 offset:24576
    ds_read_b64_tr_b16 v[90:91], v22 offset:25600
    ds_read_b64_tr_b16 v[92:93], v23 offset:24576
    ds_read_b64_tr_b16 v[94:95], v23 offset:25600
    s_waitcnt vmcnt(18) lgkmcnt(4)
    v_mfma_f32_32x32x16_bf16 v[32:47], v[80:83], a[84:87], v[32:47]
    v_mfma_f32_32x32x16_bf16 v[48:63], v[84:87], a[84:87], v[48:63]
    s_barrier
    ds_read_b64_tr_b16 v[96:97], v20 offset:0
    ds_read_b64_tr_b16 v[98:99], v20 offset:1024
    ds_read_b64_tr_b16 v[100:101], v21 offset:0
    ds_read_b64_tr_b16 v[102:103], v21 offset:1024
    s_waitcnt vmcnt(15) lgkmcnt(4)
    v_mfma_f32_32x32x16_bf16 v[32:47], v[88:91], a[88:91], v[32:47]
    s_bfe_u32 s92, s33, 262144
    s_lshl_b32 s92, s92, 11
    s_add_u32 s92, s92, s29
    buffer_load_dwordx4 v[104:107], v1, s[48:51], s92 offen sc1
    s_bfe_u32 s92, s33, 262144
    s_lshl_b32 s92, s92, 11
    s_add_u32 s92, s92, s29
    buffer_load_dwordx4 v[108:111], v1, s[48:51], s92 offen offset:1024 sc1
    s_bfe_u32 s92, s33, 262148
    s_lshl_b32 s92, s92, 11
    s_add_u32 s92, s92, s29
    buffer_load_dwordx4 v[112:115], v1, s[48:51], s92 offen sc1
    s_bfe_u32 s92, s33, 262148
    s_lshl_b32 s92, s92, 11
    s_add_u32 s92, s92, s29
    buffer_load_dwordx4 v[116:119], v1, s[48:51], s92 offen offset:1024 sc1
    v_mfma_f32_32x32x16_bf16 v[48:63], v[92:95], a[88:91], v[48:63]
    s_bfe_u32 s92, s33, 262152
    s_lshl_b32 s92, s92, 11
    s_add_u32 s92, s92, s29
    buffer_load_dwordx4 v[120:123], v1, s[48:51], s92 offen sc1
    s_bfe_u32 s92, s33, 262152
    s_lshl_b32 s92, s92, 11
    s_add_u32 s92, s92, s29
    buffer_load_dwordx4 v[124:127], v1, s[48:51], s92 offen offset:1024 sc1
    s_bfe_u32 s92, s33, 262156
    s_lshl_b32 s92, s92, 11
    s_add_u32 s92, s92, s29
    buffer_load_dwordx4 v[128:131], v1, s[48:51], s92 offen sc1
    s_bfe_u32 s92, s33, 262156
    s_lshl_b32 s92, s92, 11
    s_add_u32 s92, s92, s29
    buffer_load_dwordx4 v[132:135], v1, s[48:51], s92 offen offset:1024 sc1
    ds_read_b64_tr_b16 v[80:81], v20 offset:2048
    ds_read_b64_tr_b16 v[82:83], v20 offset:3072
    ds_read_b64_tr_b16 v[84:85], v21 offset:2048
    ds_read_b64_tr_b16 v[86:87], v21 offset:3072
    s_waitcnt vmcnt(22) lgkmcnt(4)
    v_mfma_f32_32x32x16_bf16 v[32:47], v[96:99], a[92:95], v[32:47]
    v_mfma_f32_32x32x16_bf16 v[48:63], v[100:103], a[92:95], v[48:63]
    s_barrier
    ds_read_b64_tr_b16 v[88:89], v20 offset:4096
    ds_read_b64_tr_b16 v[90:91], v20 offset:5120
    ds_read_b64_tr_b16 v[92:93], v21 offset:4096
    ds_read_b64_tr_b16 v[94:95], v21 offset:5120
    s_waitcnt vmcnt(17) lgkmcnt(4)
    v_mfma_f32_32x32x16_bf16 v[32:47], v[80:83], a[96:99], v[32:47]
    v_mfma_f32_32x32x16_bf16 v[48:63], v[84:87], a[96:99], v[48:63]
    ds_read_b64_tr_b16 v[96:97], v20 offset:6144
    ds_read_b64_tr_b16 v[98:99], v20 offset:7168
    ds_read_b64_tr_b16 v[100:101], v21 offset:6144
    ds_read_b64_tr_b16 v[102:103], v21 offset:7168
    s_waitcnt vmcnt(16) lgkmcnt(4)
    v_mfma_f32_32x32x16_bf16 v[32:47], v[88:91], a[100:103], v[32:47]
    v_mfma_f32_32x32x16_bf16 v[48:63], v[92:95], a[100:103], v[48:63]
    s_barrier
    ds_read_b64_tr_b16 v[80:81], v20 offset:8192
    ds_read_b64_tr_b16 v[82:83], v20 offset:9216
    ds_read_b64_tr_b16 v[84:85], v21 offset:8192
    ds_read_b64_tr_b16 v[86:87], v21 offset:9216
    s_waitcnt vmcnt(13) lgkmcnt(4)
    v_mfma_f32_32x32x16_bf16 v[32:47], v[96:99], a[104:107], v[32:47]
    v_mfma_f32_32x32x16_bf16 v[48:63], v[100:103], a[104:107], v[48:63]
    s_waitcnt vmcnt(0)
    v_max3_u32 v136, v104, v105, v106
    v_max3_u32 v136, v136, v107, v108
    v_max3_u32 v136, v136, v109, v110
    v_max3_u32 v136, v136, v111, v112
    v_max3_u32 v136, v136, v113, v114
    v_max3_u32 v136, v136, v115, v116
    v_max3_u32 v136, v136, v117, v118
    v_max3_u32 v136, v136, v119, v120
    v_max3_u32 v136, v136, v121, v122
    v_max3_u32 v136, v136, v123, v124
    v_max3_u32 v136, v136, v125, v126
    v_max3_u32 v136, v136, v127, v128
    v_max3_u32 v136, v136, v129, v130
    v_max3_u32 v136, v136, v131, v132
    v_max3_u32 v136, v136, v133, v134
    v_max_u32 v136, v136, v135
    v_cmp_eq_u32 vcc, -1, v136
    s_cbranch_vccz GD_23
    s_mov_b32 s91, 0x40000
GC_22:
    s_sleep 2
    s_bfe_u32 s92, s33, 262144
    s_lshl_b32 s92, s92, 11
    s_add_u32 s92, s92, s29
    buffer_load_dwordx4 v[104:107], v1, s[48:51], s92 offen sc1
    s_bfe_u32 s92, s33, 262144
    s_lshl_b32 s92, s92, 11
    s_add_u32 s92, s92, s29
    buffer_load_dwordx4 v[108:111], v1, s[48:51], s92 offen offset:1024 sc1
    s_bfe_u32 s92, s33, 262148
    s_lshl_b32 s92, s92, 11
    s_add_u32 s92, s92, s29
    buffer_load_dwordx4 v[112:115], v1, s[48:51], s92 offen sc1
    s_bfe_u32 s92, s33, 262148
    s_lshl_b32 s92, s92, 11
    s_add_u32 s92, s92, s29
    buffer_load_dwordx4 v[116:119], v1, s[48:51], s92 offen offset:1024 sc1
    s_bfe_u32 s92, s33, 262152
    s_lshl_b32 s92, s92, 11
    s_add_u32 s92, s92, s29
    buffer_load_dwordx4 v[120:123], v1, s[48:51], s92 offen sc1
    s_bfe_u32 s92, s33, 262152
    s_lshl_b32 s92, s92, 11
    s_add_u32 s92, s92, s29
    buffer_load_dwordx4 v[124:127], v1, s[48:51], s92 offen offset:1024 sc1
    s_bfe_u32 s92, s33, 262156
    s_lshl_b32 s92, s92, 11
    s_add_u32 s92, s92, s29
    buffer_load_dwordx4 v[128:131], v1, s[48:51], s92 offen sc1
    s_bfe_u32 s92, s33, 262156
    s_lshl_b32 s92, s92, 11
    s_add_u32 s92, s92, s29
    buffer_load_dwordx4 v[132:135], v1, s[48:51], s92 offen offset:1024 sc1
    s_waitcnt vmcnt(0)
    v_max3_u32 v136, v104, v105, v106
    v_max3_u32 v136, v136, v107, v108
    v_max3_u32 v136, v136, v109, v110
    v_max3_u32 v136, v136, v111, v112
    v_max3_u32 v136, v136, v113, v114
    v_max3_u32 v136, v136, v115, v116
    v_max3_u32 v136, v136, v117, v118
    v_max3_u32 v136, v136, v119, v120
    v_max3_u32 v136, v136, v121, v122
    v_max3_u32 v136, v136, v123, v124
    v_max3_u32 v136, v136, v125, v126
    v_max3_u32 v136, v136, v127, v128
    v_max3_u32 v136, v136, v129, v130
    v_max3_u32 v136, v136, v131, v132
    v_max3_u32 v136, v136, v133, v134
    v_max_u32 v136, v136, v135
    v_cmp_eq_u32 vcc, -1, v136
    s_cbranch_vccz GD_23
    s_sub_u32 s91, s91, 1
    s_cmp_eq_u32 s91, 0
    s_cbranch_scc1 GD_23
    s_branch GC_22
GD_23:
    ds_read_b64_tr_b16 v[88:89], v20 offset:10240
    ds_read_b64_tr_b16 v[90:91], v20 offset:11264
    ds_read_b64_tr_b16 v[92:93], v21 offset:10240
    ds_read_b64_tr_b16 v[94:95], v21 offset:11264
    s_waitcnt lgkmcnt(4)
    v_mfma_f32_32x32x16_bf16 v[32:47], v[80:83], a[108:111], v[32:47]
    v_mfma_f32_32x32x16_bf16 v[48:63], v[84:87], a[108:111], v[48:63]
    s_nop 10
    v_mul_f32 v32, v32, v138
    v_mul_f32 v33, v33, v138
    v_mul_f32 v34, v34, v138
    v_mul_f32 v35, v35, v138
    v_mul_f32 v36, v36, v138
    v_mul_f32 v37, v37, v138
    v_mul_f32 v38, v38, v138
    v_mul_f32 v39, v39, v138
    v_mul_f32 v40, v40, v138
    v_mul_f32 v41, v41, v138
    v_mul_f32 v42, v42, v138
    v_mul_f32 v43, v43, v138
    v_mul_f32 v44, v44, v138
    v_mul_f32 v45, v45, v138
    v_mul_f32 v46, v46, v138
    v_mul_f32 v47, v47, v138
    v_mul_f32 v48, v48, v138
    v_mul_f32 v49, v49, v138
    v_mul_f32 v50, v50, v138
    v_mul_f32 v51, v51, v138
    v_mul_f32 v52, v52, v138
    v_mul_f32 v53, v53, v138
    v_mul_f32 v54, v54, v138
    v_mul_f32 v55, v55, v138
    v_mul_f32 v56, v56, v138
    v_mul_f32 v57, v57, v138
    v_mul_f32 v58, v58, v138
    v_mul_f32 v59, v59, v138
    v_mul_f32 v60, v60, v138
    v_mul_f32 v61, v61, v138
    v_mul_f32 v62, v62, v138
    v_mul_f32 v63, v63, v138
    s_barrier
    ds_read_b64_tr_b16 v[96:97], v22 offset:6144
    ds_read_b64_tr_b16 v[98:99], v22 offset:7168
    ds_read_b64_tr_b16 v[100:101], v23 offset:6144
    ds_read_b64_tr_b16 v[102:103], v23 offset:7168
    s_waitcnt lgkmcnt(4)
    v_mfma_f32_32x32x16_bf16 v[32:47], v[88:91], v[104:107], v[32:47]
    v_mfma_f32_32x32x16_bf16 v[48:63], v[92:95], v[104:107], v[48:63]
    ds_read_b64_tr_b16 v[80:81], v22 offset:10240
    ds_read_b64_tr_b16 v[82:83], v22 offset:11264
    ds_read_b64_tr_b16 v[84:85], v23 offset:10240
    ds_read_b64_tr_b16 v[86:87], v23 offset:11264
    s_waitcnt lgkmcnt(4)
    v_mfma_f32_32x32x16_bf16 v[32:47], v[96:99], v[108:111], v[32:47]
    v_mfma_f32_32x32x16_bf16 v[48:63], v[100:103], v[108:111], v[48:63]
    s_barrier
    ds_read_b64_tr_b16 v[88:89], v22 offset:14336
    ds_read_b64_tr_b16 v[90:91], v22 offset:15360
    ds_read_b64_tr_b16 v[92:93], v23 offset:14336
    ds_read_b64_tr_b16 v[94:95], v23 offset:15360
    s_waitcnt lgkmcnt(4)
    v_mfma_f32_32x32x16_bf16 v[32:47], v[80:83], v[112:115], v[32:47]
    v_mfma_f32_32x32x16_bf16 v[48:63], v[84:87], v[112:115], v[48:63]
    ds_read_b64_tr_b16 v[96:97], v22 offset:18432
    ds_read_b64_tr_b16 v[98:99], v22 offset:19456
    ds_read_b64_tr_b16 v[100:101], v23 offset:18432
    ds_read_b64_tr_b16 v[102:103], v23 offset:19456
    s_waitcnt lgkmcnt(4)
    v_mfma_f32_32x32x16_bf16 v[32:47], v[88:91], v[116:119], v[32:47]
    v_mfma_f32_32x32x16_bf16 v[48:63], v[92:95], v[116:119], v[48:63]
    s_barrier
    ds_read_b64_tr_b16 v[80:81], v22 offset:22528
    ds_read_b64_tr_b16 v[82:83], v22 offset:23552
    ds_read_b64_tr_b16 v[84:85], v23 offset:22528
    ds_read_b64_tr_b16 v[86:87], v23 offset:23552
    s_waitcnt lgkmcnt(4)
    v_mfma_f32_32x32x16_bf16 v[32:47], v[96:99], v[120:123], v[32:47]
    v_mfma_f32_32x32x16_bf16 v[48:63], v[100:103], v[120:123], v[48:63]
    ds_read_b64_tr_b16 v[88:89], v22 offset:0
    ds_read_b64_tr_b16 v[90:91], v22 offset:1024
    ds_read_b64_tr_b16 v[92:93], v23 offset:0
    ds_read_b64_tr_b16 v[94:95], v23 offset:1024
    s_waitcnt lgkmcnt(4)
    v_mfma_f32_32x32x16_bf16 v[32:47], v[80:83], v[124:127], v[32:47]
    v_mfma_f32_32x32x16_bf16 v[48:63], v[84:87], v[124:127], v[48:63]
    ds_read_b64_tr_b16 v[96:97], v22 offset:2048
    ds_read_b64_tr_b16 v[98:99], v22 offset:3072
    ds_read_b64_tr_b16 v[100:101], v23 offset:2048
    ds_read_b64_tr_b16 v[102:103], v23 offset:3072
    s_waitcnt lgkmcnt(4)
    v_mfma_f32_32x32x16_bf16 v[32:47], v[88:91], v[128:131], v[32:47]
    v_mfma_f32_32x32x16_bf16 v[48:63], v[92:95], v[128:131], v[48:63]
    s_waitcnt lgkmcnt(0)
    v_mfma_f32_32x32x16_bf16 v[32:47], v[96:99], v[132:135], v[32:47]
    v_mfma_f32_32x32x16_bf16 v[48:63], v[100:103], v[132:135], v[48:63]
    s_barrier
    s_lshl_b32 s87, s74, 13
    v_add_u32 v30, s87, v1
    s_nop 7
    ds_write_b128 v30, v[32:35] offset:0
    ds_write_b128 v30, v[36:39] offset:1024
    ds_write_b128 v30, v[40:43] offset:2048
    ds_write_b128 v30, v[44:47] offset:3072
    ds_write_b128 v30, v[48:51] offset:4096
    ds_write_b128 v30, v[52:55] offset:5120
    ds_write_b128 v30, v[56:59] offset:6144
    ds_write_b128 v30, v[60:63] offset:7168
    s_waitcnt lgkmcnt(0)
    s_barrier
    s_lshl_b32 s87, s79, 15
    s_bfe_u32 s88, s74, 0x10001
    s_lshl_b32 s89, s88, 12
    s_add_u32 s87, s87, s89
    s_and_b32 s89, s74, 1
    s_lshl_b32 s92, s89, 11
    s_add_u32 s87, s87, s92
    v_add_u32 v30, s87, v1
    ds_read_b128 v[64:67], v30 offset:0
    ds_read_b128 v[68:71], v30 offset:1024
    ds_read_b128 v[72:75], v30 offset:8192
    ds_read_b128 v[76:79], v30 offset:9216
    ds_read_b128 v[80:83], v30 offset:16384
    ds_read_b128 v[84:87], v30 offset:17408
    ds_read_b128 v[88:91], v30 offset:24576
    ds_read_b128 v[92:95], v30 offset:25600
    s_add_u32 s87, s77, s79
    s_mul_i32 s87, s87, 28672
    s_lshl_b32 s92, s76, 7
    s_add_u32 s87, s87, s92
    s_lshl_b32 s88, s88, 6
    s_add_u32 s87, s87, s88
    s_lshl_b32 s89, s89, 5
    s_add_u32 s87, s87, s89
    v_and_b32 v31, 31, v0
    v_mul_u32_u24 v31, 896, v31
    v_lshrrev_b32 v136, 5, v0
    v_lshl_add_u32 v31, v136, 4, v31
    s_waitcnt lgkmcnt(4)
    v_add_f32 v64, v64, v72
    v_add_f32 v65, v65, v73
    v_add_f32 v66, v66, v74
    v_add_f32 v67, v67, v75
    v_add_f32 v68, v68, v76
    v_add_f32 v69, v69, v77
    v_add_f32 v70, v70, v78
    v_add_f32 v71, v71, v79
    s_waitcnt lgkmcnt(0)
    v_add_f32 v80, v80, v88
    v_add_f32 v81, v81, v89
    v_add_f32 v82, v82, v90
    v_add_f32 v83, v83, v91
    v_add_f32 v84, v84, v92
    v_add_f32 v85, v85, v93
    v_add_f32 v86, v86, v94
    v_add_f32 v87, v87, v95
    v_add_f32 v64, v64, v80
    v_add_f32 v65, v65, v81
    v_add_f32 v66, v66, v82
    v_add_f32 v67, v67, v83
    v_add_f32 v68, v68, v84
    v_add_f32 v69, v69, v85
    v_add_f32 v70, v70, v86
    v_add_f32 v71, v71, v87
    v_cvt_pk_bf16_f32 v96, v64, v65
    v_cvt_pk_bf16_f32 v97, v66, v67
    v_cvt_pk_bf16_f32 v98, v68, v69
    v_cvt_pk_bf16_f32 v99, v70, v71
    s_nop 0
    v_permlane32_swap_b32 v96, v98
    v_permlane32_swap_b32 v97, v99
    buffer_store_dwordx4 v[96:99], v31, s[60:63], s87 offen
END:
    s_endpgm
.section .rodata,"a"
.p2align 6
.amdhsa_kernel gated_mix__linear_kernel_hedgehog__dense_activation_silu__prompt_kernel
  .amdhsa_next_free_vgpr 256
  .amdhsa_next_free_sgpr 102
  .amdhsa_accum_offset 144
  .amdhsa_group_segment_fixed_size 0
  .amdhsa_kernarg_size 88
  .amdhsa_user_sgpr_count 2
  .amdhsa_user_sgpr_kernarg_segment_ptr 1
  .amdhsa_system_sgpr_workgroup_id_x 1
.end_amdhsa_kernel
```
